```python
import torch

def _softmax(x, axis=-1):
    return torch.softmax(x, dim=axis)
def _gelu(x):
    return torch.nn.functional.gelu(x, approximate="tanh")
def _silu(x):
    return torch.nn.functional.silu(x)
def _sigmoid(x):
    return torch.sigmoid(x)
def _layernorm(x, axis=-1, eps=1e-5):
    m = x.mean(dim=axis, keepdim=True)
    v = x.var(dim=axis, keepdim=True, unbiased=False)
    return (x - m) / torch.sqrt(v + eps)
def _scatter_add(tgt, idx, src, axis=0):
    return tgt.clone().index_add_(axis, idx, src)
def _segment_sum(src, seg, n):
    out = torch.zeros((n,) + src.shape[1:], dtype=src.dtype)
    return out.index_add_(0, seg, src)
def _pad(x, pw):
    flat = tuple(v for pair in reversed(pw) for v in pair)
    return torch.nn.functional.pad(x, flat)

kernel_name = 'parallel_sum__mha_block_cached__glu_gated_bilinear__decode'

def setup_inputs():

    _w = (lambda a: (lambda t: t.to(torch.bfloat16) if t.is_floating_point() else t)(torch.as_tensor(a)))
    def _A_setup():
        B, Sq, D = 1, 1, 576
        H, Sk, Dh = 32, 16384, 128
        return {
            "x": _w((lambda *s: torch.randn(*s, dtype=torch.bfloat16) * 0.05)(B, Sq, D)),
            "k_cache": _w((lambda *s: torch.randn(*s, dtype=torch.bfloat16) * 3.2)(B, H, Sk, Dh)),
            "v_cache": _w((lambda *s: torch.randn(*s, dtype=torch.bfloat16) * 1.6)(B, H, Sk, Dh)),
            "wq": _w((lambda *s: torch.randn(*s, dtype=torch.bfloat16) * 3.2)(D, H * Dh) * (D ** -0.5)),
            "wo": _w((lambda *s: torch.randn(*s, dtype=torch.bfloat16) * 1.6)(H * Dh, D) * ((H * Dh) ** -0.5)),
        }
    _A_in = _A_setup()

    def _B_setup():
        B, S, D, F = 1, 1, 576, 4608
        return {
            "x": _w((lambda *s: torch.randn(*s, dtype=torch.bfloat16) * 0.05)(B, S, D)),
            "w_gate": _w((lambda *s: torch.randn(*s, dtype=torch.bfloat16) * 1.6)(D, F) * (D ** -0.5)),
            "w_up": _w((lambda *s: torch.randn(*s, dtype=torch.bfloat16) * 1.6)(D, F) * (D ** -0.5)),
            "w_down": _w((lambda *s: torch.randn(*s, dtype=torch.bfloat16) * 1.6)(F, D) * (F ** -0.5)),
        }
    _B_in = _B_setup()

    return {
        "A_x": _A_in["x"],
        "A_k_cache": _A_in["k_cache"],
        "A_v_cache": _A_in["v_cache"],
        "A_wq": _A_in["wq"],
        "A_wo": _A_in["wo"],
        "B_x": _B_in["x"],
        "B_w_gate": _B_in["w_gate"],
        "B_w_up": _B_in["w_up"],
        "B_w_down": _B_in["w_down"],
    }

def reference(A_x, A_k_cache, A_v_cache, A_wq, A_wo, B_x, B_w_gate, B_w_up, B_w_down):
    def _A_ref(x, k_cache, v_cache, wq, wo):
        B, Sq, D = x.shape
        H, Dh = 32, 128
        q = (lambda x, *d: x.permute(*d))((x @ wq).reshape(B, Sq, H, Dh), 0, 2, 1, 3)
        scores = torch.einsum("bhqd,bhkd->bhqk", q, k_cache) * (Dh ** -0.5)
        p = _softmax(scores, axis=-1)
        o = torch.einsum("bhqk,bhkd->bhqd", p, v_cache)
        return (lambda x, *d: x.permute(*d))(o, 0, 2, 1, 3).reshape(B, Sq, H * Dh) @ wo

    def _B_ref(x, w_gate, w_up, w_down):
        g = torch.einsum("bsd,df->bsf", x, w_gate)
        u = torch.einsum("bsd,df->bsf", x, w_up)
        h = g * u
        return torch.einsum("bsf,fd->bsd", h, w_down)

    x = A_x
    xn = _layernorm(x, axis=-1)
    return x + _A_ref(xn, A_k_cache, A_v_cache, A_wq, A_wo) + _B_ref(xn, B_w_gate, B_w_up, B_w_down)
```

```asm
; @launch grid=(256,1,1) block=(512,1,1) lds=20480
.amdgcn_target "amdgcn-amd-amdhsa--gfx950"
.text
.globl parallel_sum__mha_block_cached__glu_gated_bilinear__decode_kernel
.p2align 8
.type parallel_sum__mha_block_cached__glu_gated_bilinear__decode_kernel,@function
parallel_sum__mha_block_cached__glu_gated_bilinear__decode_kernel:
  s_cmp_ge_u32 s2, 256
  s_cbranch_scc1 L_end
  s_load_dwordx16 s[16:31], s[0:1], 0
  s_load_dwordx8 s[32:39], s[0:1], 64
  v_lshrrev_b32 v8, 6, v0
  v_and_b32 v1, 63, v0
  v_readfirstlane_b32 s3, v8
  v_lshrrev_b32 v2, 4, v1
  v_and_b32 v3, 15, v1
  s_and_b32 s10, s2, 7
  s_lshr_b32 s11, s2, 3
  s_and_b32 s4, s11, 3
  s_lshr_b32 s5, s11, 2
  s_lshl_b32 s10, s10, 2
  s_add_u32 s4, s4, s10
  s_lshl_b32 s6, s4, 3
  s_add_u32 s6, s6, s5
  s_cmp_ge_u32 s3, 4
  s_cbranch_scc1 L_helper
  s_lshl_b32 s10, s6, 19
  s_lshl_b32 s11, s3, 10
  s_add_u32 s10, s10, s11
  v_lshrrev_b32 v8, 2, v3
  v_lshlrev_b32 v8, 8, v8
  v_and_b32 v11, 3, v3
  v_lshlrev_b32 v11, 4, v11
  v_lshlrev_b32 v12, 6, v2
  v_add3_u32 v8, v8, v11, v12
  v_add_u32 v46, s10, v8
  s_mov_b32 s8, 0
  s_mov_b32 s46, 0x8000000
  s_mov_b32 s47, 0x20000
  s_waitcnt lgkmcnt(0)
  s_mov_b32 s44, s18
  s_mov_b32 s45, s19
  buffer_load_dwordx4 v[128:131], v46, s[44:47], s8 offen nt
  s_add_u32 s8, s8, 4096
  buffer_load_dwordx4 v[132:135], v46, s[44:47], s8 offen nt
  s_add_u32 s8, s8, 4096
  buffer_load_dwordx4 v[136:139], v46, s[44:47], s8 offen nt
  s_add_u32 s8, s8, 4096
  buffer_load_dwordx4 v[140:143], v46, s[44:47], s8 offen nt
  s_add_u32 s8, s8, 4096
  buffer_load_dwordx4 v[144:147], v46, s[44:47], s8 offen nt
  s_add_u32 s8, s8, 4096
  buffer_load_dwordx4 v[148:151], v46, s[44:47], s8 offen nt
  s_add_u32 s8, s8, 4096
  s_branch L_stream2
L_helper:
  s_sub_u32 s7, s3, 4
  v_lshlrev_b32 v8, 2, v1
  v_lshl_add_u32 v9, v3, 2, v2
  v_and_b32 v9, -2, v9
  v_lshlrev_b32 v9, 1, v9
  s_mul_i32 s10, s5, 144
  s_and_b32 s11, s5, 3
  s_lshl_b32 s11, s11, 2
  s_add_u32 s74, s11, s7
  s_mul_i32 s11, s74, 72
  s_mov_b32 s12, 5898240
  s_waitcnt lgkmcnt(0)
  s_load_dword s15, s[38:39], s12
  s_memrealtime s[78:79]
  s_mov_b32 s40, s16
  s_mov_b32 s41, s17
  s_mov_b32 s42, 1152
  s_mov_b32 s43, 0x20000
  buffer_load_dword v48, v8, s[40:43], 0 offen offset:0
  buffer_load_dword v49, v8, s[40:43], 0 offen offset:256
  buffer_load_dword v50, v8, s[40:43], 0 offen offset:512
  buffer_load_dword v51, v8, s[40:43], 0 offen offset:768
  buffer_load_dword v52, v8, s[40:43], 0 offen offset:1024
  buffer_load_dword v56, v9, s[40:43], s10 offen offset:0
  buffer_load_dword v57, v9, s[40:43], s10 offen offset:128
  buffer_load_dword v58, v9, s[40:43], s11 offen
  s_cmp_lg_u32 s7, 0
  s_cbranch_scc1 L_x13
  s_mov_b32 s48, s22
  s_mov_b32 s49, s23
  s_mov_b32 s50, 4718592
  s_mov_b32 s51, 0x20000
  s_mul_i32 s10, s5, 589824
  s_lshl_b32 s11, s4, 8
  s_add_u32 s8, s10, s11
  v_lshlrev_b32 v8, 13, v2
  v_lshl_add_u32 v10, v3, 4, v8
  buffer_load_dwordx4 v[96:99], v10, s[48:51], s8 offen nt
  s_add_u32 s8, s8, 32768
  buffer_load_dwordx4 v[100:103], v10, s[48:51], s8 offen nt
  s_add_u32 s8, s8, 32768
  buffer_load_dwordx4 v[104:107], v10, s[48:51], s8 offen nt
  s_add_u32 s8, s8, 32768
  buffer_load_dwordx4 v[108:111], v10, s[48:51], s8 offen nt
  s_add_u32 s8, s8, 32768
  buffer_load_dwordx4 v[112:115], v10, s[48:51], s8 offen nt
  s_add_u32 s8, s8, 32768
  buffer_load_dwordx4 v[116:119], v10, s[48:51], s8 offen nt
  s_add_u32 s8, s8, 32768
  buffer_load_dwordx4 v[120:123], v10, s[48:51], s8 offen nt
  s_add_u32 s8, s8, 32768
  buffer_load_dwordx4 v[124:127], v10, s[48:51], s8 offen nt
  s_add_u32 s8, s8, 32768
  buffer_load_dwordx4 v[128:131], v10, s[48:51], s8 offen nt
  s_add_u32 s8, s8, 32768
  buffer_load_dwordx4 v[132:135], v10, s[48:51], s8 offen nt
  s_add_u32 s8, s8, 32768
  buffer_load_dwordx4 v[136:139], v10, s[48:51], s8 offen nt
  s_add_u32 s8, s8, 32768
  buffer_load_dwordx4 v[140:143], v10, s[48:51], s8 offen nt
  s_add_u32 s8, s8, 32768
  buffer_load_dwordx4 v[144:147], v10, s[48:51], s8 offen nt
  s_add_u32 s8, s8, 32768
  buffer_load_dwordx4 v[148:151], v10, s[48:51], s8 offen nt
  s_add_u32 s8, s8, 32768
  buffer_load_dwordx4 v[152:155], v10, s[48:51], s8 offen nt
  s_add_u32 s8, s8, 32768
  buffer_load_dwordx4 v[156:159], v10, s[48:51], s8 offen nt
  s_add_u32 s8, s8, 32768
  buffer_load_dwordx4 v[160:163], v10, s[48:51], s8 offen nt
  s_add_u32 s8, s8, 32768
  buffer_load_dwordx4 v[164:167], v10, s[48:51], s8 offen nt
  s_add_u32 s8, s8, 32768
L_x13:
  s_cmp_lg_u32 s7, 3
  s_cbranch_scc1 L_nopf
  s_cmp_ge_u32 s2, 16
  s_cbranch_scc1 L_nopf
  s_getpc_b64 s[76:77]
L_pfbase:
  s_sub_u32 s76, s76, L_pfbase-parallel_sum__mha_block_cached__glu_gated_bilinear__decode_kernel
  s_subb_u32 s77, s77, 0
  v_lshlrev_b32 v8, 7, v1
  global_load_dword v12, v8, s[76:77]
  v_add_u32 v8, 0x2000, v8
  v_cmp_gt_i32 vcc, (L_codeend-parallel_sum__mha_block_cached__glu_gated_bilinear__decode_kernel-8192)/128, v1
  s_and_saveexec_b64 s[72:73], vcc
  s_cbranch_execz L_pf2
  global_load_dword v13, v8, s[76:77]
  v_add_u32 v8, 0x2000, v8
  v_cmp_gt_i32 vcc, (L_codeend-parallel_sum__mha_block_cached__glu_gated_bilinear__decode_kernel-16384)/128, v1
  s_and_saveexec_b64 s[72:73], vcc
  s_cbranch_execz L_pf2
  global_load_dword v14, v8, s[76:77]
L_pf2:
  s_mov_b64 exec, -1
  s_waitcnt vmcnt(0)
L_nopf:
  s_cmp_lt_u32 s2, 128
  s_cselect_b32 s56, s28, s30
  s_cselect_b32 s57, s29, s31
  s_mov_b32 s58, 5308416
  s_mov_b32 s59, 0x20000
  s_mul_i32 s12, 0, 288
  v_mul_u32_u24 v8, 9216, v2
  v_lshl_add_u32 v8, v3, 4, v8
  v_add_u32 v60, s12, v8
  v_add_u32 v8, 256, v60
  v_mov_b32 v9, 1073741824
  v_cmp_gt_u32 vcc, 2, v3
  s_nop 1
  v_cndmask_b32 v61, v9, v8, vcc
  s_mul_i32 s8, s74, 331776
  s_mul_i32 s10, s4, 288
  s_add_u32 s8, s8, s10
  s_mov_b32 s52, s38
  s_mov_b32 s53, s39
  s_mov_b32 s54, 12582912
  s_mov_b32 s55, 0x20000
  v_and_b32 v8, 1, v3
  v_lshlrev_b32 v8, 4, v8
  s_mov_b32 s10, 0xffff
  v_lshlrev_b32 v8, v8, s10
  v_lshrrev_b32 v11, 1, v3
  v_cmp_eq_u32 vcc, 0, v11
  s_nop 1
  v_cndmask_b32 v4, 0, v8, vcc
  v_cmp_eq_u32 vcc, 1, v11
  s_nop 1
  v_cndmask_b32 v5, 0, v8, vcc
  v_cmp_eq_u32 vcc, 2, v11
  s_nop 1
  v_cndmask_b32 v6, 0, v8, vcc
  v_cmp_eq_u32 vcc, 3, v11
  s_nop 1
  v_cndmask_b32 v7, 0, v8, vcc
  s_cmp_lg_u32 s7, 0
  s_cbranch_scc1 L_x13b
  s_waitcnt vmcnt(18)
  s_branch L_ln
L_x13b:
  s_waitcnt vmcnt(0)
L_ln:
  v_lshlrev_b32 v68, 16, v48
  v_and_b32 v69, 0xffff0000, v48
  v_lshlrev_b32 v70, 16, v49
  v_and_b32 v71, 0xffff0000, v49
  v_lshlrev_b32 v72, 16, v50
  v_and_b32 v73, 0xffff0000, v50
  v_lshlrev_b32 v74, 16, v51
  v_and_b32 v75, 0xffff0000, v51
  v_lshlrev_b32 v76, 16, v52
  v_and_b32 v77, 0xffff0000, v52
  v_add_f32 v8, v68, v69
  v_add_f32 v8, v8, v70
  v_add_f32 v8, v8, v71
  v_add_f32 v8, v8, v72
  v_add_f32 v8, v8, v73
  v_add_f32 v8, v8, v74
  v_add_f32 v8, v8, v75
  v_add_f32 v8, v8, v76
  v_add_f32 v8, v8, v77
  s_nop 1
  v_add_f32_dpp v8, v8, v8 row_shr:1 row_mask:0xf bank_mask:0xf
  s_nop 1
  v_add_f32_dpp v8, v8, v8 row_shr:2 row_mask:0xf bank_mask:0xf
  s_nop 1
  v_add_f32_dpp v8, v8, v8 row_shr:4 row_mask:0xf bank_mask:0xf
  s_nop 1
  v_add_f32_dpp v8, v8, v8 row_shr:8 row_mask:0xf bank_mask:0xf
  s_nop 1
  v_add_f32_dpp v8, v8, v8 row_bcast:15 row_mask:0xa bank_mask:0xf
  s_nop 1
  v_add_f32_dpp v8, v8, v8 row_bcast:31 row_mask:0xc bank_mask:0xf
  s_nop 1
  v_mul_f32 v8, 987991609, v8
  v_cmp_gt_u32 vcc, 32, v1
  v_readlane_b32 s10, v8, 63
  s_nop 1
  v_subrev_f32 v68, s10, v68
  v_subrev_f32 v69, s10, v69
  v_subrev_f32 v70, s10, v70
  v_subrev_f32 v71, s10, v71
  v_subrev_f32 v72, s10, v72
  v_subrev_f32 v73, s10, v73
  v_subrev_f32 v74, s10, v74
  v_subrev_f32 v75, s10, v75
  v_subrev_f32 v76, s10, v76
  v_subrev_f32 v77, s10, v77
  v_cndmask_b32 v76, 0, v76, vcc
  v_cndmask_b32 v77, 0, v77, vcc
  v_mul_f32 v9, v68, v68
  v_fmac_f32 v9, v69, v69
  v_fmac_f32 v9, v70, v70
  v_fmac_f32 v9, v71, v71
  v_fmac_f32 v9, v72, v72
  v_fmac_f32 v9, v73, v73
  v_fmac_f32 v9, v74, v74
  v_fmac_f32 v9, v75, v75
  v_fmac_f32 v9, v76, v76
  v_fmac_f32 v9, v77, v77
  s_nop 1
  v_add_f32_dpp v9, v9, v9 row_shr:1 row_mask:0xf bank_mask:0xf
  s_nop 1
  v_add_f32_dpp v9, v9, v9 row_shr:2 row_mask:0xf bank_mask:0xf
  s_nop 1
  v_add_f32_dpp v9, v9, v9 row_shr:4 row_mask:0xf bank_mask:0xf
  s_nop 1
  v_add_f32_dpp v9, v9, v9 row_shr:8 row_mask:0xf bank_mask:0xf
  s_nop 1
  v_add_f32_dpp v9, v9, v9 row_bcast:15 row_mask:0xa bank_mask:0xf
  s_nop 1
  v_add_f32_dpp v9, v9, v9 row_bcast:31 row_mask:0xc bank_mask:0xf
  s_nop 1
  v_mul_f32 v9, 987991609, v9
  v_cvt_pk_bf16_f32 v9, v9, v9
  v_lshlrev_b32 v9, 16, v9
  v_add_f32 v9, 925353388, v9
  v_cvt_pk_bf16_f32 v9, v9, v9
  v_lshlrev_b32 v9, 16, v9
  v_sqrt_f32 v9, v9
  s_nop 0
  v_cvt_pk_bf16_f32 v9, v9, v9
  v_lshlrev_b32 v9, 16, v9
  v_rcp_f32 v9, v9
  v_cvt_pk_bf16_f32 v8, v8, v8
  v_lshlrev_b32 v8, 16, v8
  s_nop 0
  v_readlane_b32 s10, v8, 63
  v_readlane_b32 s11, v9, 63
  v_and_b32 v10, 1, v2
  v_lshlrev_b32 v10, 4, v10
  v_lshrrev_b32 v56, v10, v56
  v_lshlrev_b32 v56, 16, v56
  v_subrev_f32 v56, s10, v56
  v_cvt_pk_bf16_f32 v56, v56, v56
  v_lshlrev_b32 v56, 16, v56
  v_mul_f32 v56, s11, v56
  v_cvt_pk_bf16_f32 v56, v56, v56
  v_lshrrev_b32 v57, v10, v57
  v_lshlrev_b32 v57, 16, v57
  v_subrev_f32 v57, s10, v57
  v_cvt_pk_bf16_f32 v57, v57, v57
  v_lshlrev_b32 v57, 16, v57
  v_mul_f32 v57, s11, v57
  v_cvt_pk_bf16_f32 v57, v57, v57
  v_lshrrev_b32 v58, v10, v58
  v_lshlrev_b32 v58, 16, v58
  v_subrev_f32 v58, s10, v58
  v_cvt_pk_bf16_f32 v58, v58, v58
  v_lshlrev_b32 v58, 16, v58
  v_mul_f32 v58, s11, v58
  v_cvt_pk_bf16_f32 v58, v58, v58
  s_waitcnt lgkmcnt(0)
  s_add_u32 s15, s15, 2654435769
  s_getreg_b32 s75, hwreg(HW_REG_XCC_ID)
  s_and_b32 s75, s75, 7
  s_and_b32 s46, s2, 7
  s_xor_b32 s46, s46, s75
  s_xor_b32 s75, s75, s15
  s_cmp_lg_u32 s7, 0
  s_cbranch_scc1 L_noq
  v_and_b32_dpp v20, v56, v4 row_newbcast:0 row_mask:0xf bank_mask:0xf
  v_and_b32_dpp v21, v56, v5 row_newbcast:0 row_mask:0xf bank_mask:0xf
  v_and_b32_dpp v22, v56, v6 row_newbcast:0 row_mask:0xf bank_mask:0xf
  v_and_b32_dpp v23, v56, v7 row_newbcast:0 row_mask:0xf bank_mask:0xf
  s_waitcnt vmcnt(17)
  s_nop 0
  v_mfma_f32_16x16x32_bf16 v[24:27], v[20:23], v[96:99], 0
  v_and_b32_dpp v16, v56, v4 row_newbcast:1 row_mask:0xf bank_mask:0xf
  v_and_b32_dpp v17, v56, v5 row_newbcast:1 row_mask:0xf bank_mask:0xf
  v_and_b32_dpp v18, v56, v6 row_newbcast:1 row_mask:0xf bank_mask:0xf
  v_and_b32_dpp v19, v56, v7 row_newbcast:1 row_mask:0xf bank_mask:0xf
  s_waitcnt vmcnt(16)
  s_nop 0
  v_mfma_f32_16x16x32_bf16 v[24:27], v[16:19], v[100:103], v[24:27]
  v_and_b32_dpp v20, v56, v4 row_newbcast:2 row_mask:0xf bank_mask:0xf
  v_and_b32_dpp v21, v56, v5 row_newbcast:2 row_mask:0xf bank_mask:0xf
  v_and_b32_dpp v22, v56, v6 row_newbcast:2 row_mask:0xf bank_mask:0xf
  v_and_b32_dpp v23, v56, v7 row_newbcast:2 row_mask:0xf bank_mask:0xf
  s_waitcnt vmcnt(15)
  s_nop 0
  v_mfma_f32_16x16x32_bf16 v[24:27], v[20:23], v[104:107], v[24:27]
  v_and_b32_dpp v16, v56, v4 row_newbcast:3 row_mask:0xf bank_mask:0xf
  v_and_b32_dpp v17, v56, v5 row_newbcast:3 row_mask:0xf bank_mask:0xf
  v_and_b32_dpp v18, v56, v6 row_newbcast:3 row_mask:0xf bank_mask:0xf
  v_and_b32_dpp v19, v56, v7 row_newbcast:3 row_mask:0xf bank_mask:0xf
  s_waitcnt vmcnt(14)
  s_nop 0
  v_mfma_f32_16x16x32_bf16 v[24:27], v[16:19], v[108:111], v[24:27]
  v_and_b32_dpp v20, v56, v4 row_newbcast:4 row_mask:0xf bank_mask:0xf
  v_and_b32_dpp v21, v56, v5 row_newbcast:4 row_mask:0xf bank_mask:0xf
  v_and_b32_dpp v22, v56, v6 row_newbcast:4 row_mask:0xf bank_mask:0xf
  v_and_b32_dpp v23, v56, v7 row_newbcast:4 row_mask:0xf bank_mask:0xf
  s_waitcnt vmcnt(13)
  s_nop 0
  v_mfma_f32_16x16x32_bf16 v[24:27], v[20:23], v[112:115], v[24:27]
  v_and_b32_dpp v16, v56, v4 row_newbcast:5 row_mask:0xf bank_mask:0xf
  v_and_b32_dpp v17, v56, v5 row_newbcast:5 row_mask:0xf bank_mask:0xf
  v_and_b32_dpp v18, v56, v6 row_newbcast:5 row_mask:0xf bank_mask:0xf
  v_and_b32_dpp v19, v56, v7 row_newbcast:5 row_mask:0xf bank_mask:0xf
  s_waitcnt vmcnt(12)
  s_nop 0
  v_mfma_f32_16x16x32_bf16 v[24:27], v[16:19], v[116:119], v[24:27]
  v_and_b32_dpp v20, v56, v4 row_newbcast:6 row_mask:0xf bank_mask:0xf
  v_and_b32_dpp v21, v56, v5 row_newbcast:6 row_mask:0xf bank_mask:0xf
  v_and_b32_dpp v22, v56, v6 row_newbcast:6 row_mask:0xf bank_mask:0xf
  v_and_b32_dpp v23, v56, v7 row_newbcast:6 row_mask:0xf bank_mask:0xf
  s_waitcnt vmcnt(11)
  s_nop 0
  v_mfma_f32_16x16x32_bf16 v[24:27], v[20:23], v[120:123], v[24:27]
  v_and_b32_dpp v16, v56, v4 row_newbcast:7 row_mask:0xf bank_mask:0xf
  v_and_b32_dpp v17, v56, v5 row_newbcast:7 row_mask:0xf bank_mask:0xf
  v_and_b32_dpp v18, v56, v6 row_newbcast:7 row_mask:0xf bank_mask:0xf
  v_and_b32_dpp v19, v56, v7 row_newbcast:7 row_mask:0xf bank_mask:0xf
  s_waitcnt vmcnt(10)
  s_nop 0
  v_mfma_f32_16x16x32_bf16 v[24:27], v[16:19], v[124:127], v[24:27]
  v_and_b32_dpp v20, v56, v4 row_newbcast:8 row_mask:0xf bank_mask:0xf
  v_and_b32_dpp v21, v56, v5 row_newbcast:8 row_mask:0xf bank_mask:0xf
  v_and_b32_dpp v22, v56, v6 row_newbcast:8 row_mask:0xf bank_mask:0xf
  v_and_b32_dpp v23, v56, v7 row_newbcast:8 row_mask:0xf bank_mask:0xf
  s_waitcnt vmcnt(9)
  s_nop 0
  v_mfma_f32_16x16x32_bf16 v[24:27], v[20:23], v[128:131], v[24:27]
  v_and_b32_dpp v16, v56, v4 row_newbcast:9 row_mask:0xf bank_mask:0xf
  v_and_b32_dpp v17, v56, v5 row_newbcast:9 row_mask:0xf bank_mask:0xf
  v_and_b32_dpp v18, v56, v6 row_newbcast:9 row_mask:0xf bank_mask:0xf
  v_and_b32_dpp v19, v56, v7 row_newbcast:9 row_mask:0xf bank_mask:0xf
  s_waitcnt vmcnt(8)
  s_nop 0
  v_mfma_f32_16x16x32_bf16 v[24:27], v[16:19], v[132:135], v[24:27]
  v_and_b32_dpp v20, v56, v4 row_newbcast:10 row_mask:0xf bank_mask:0xf
  v_and_b32_dpp v21, v56, v5 row_newbcast:10 row_mask:0xf bank_mask:0xf
  v_and_b32_dpp v22, v56, v6 row_newbcast:10 row_mask:0xf bank_mask:0xf
  v_and_b32_dpp v23, v56, v7 row_newbcast:10 row_mask:0xf bank_mask:0xf
  s_waitcnt vmcnt(7)
  s_nop 0
  v_mfma_f32_16x16x32_bf16 v[24:27], v[20:23], v[136:139], v[24:27]
  v_and_b32_dpp v16, v56, v4 row_newbcast:11 row_mask:0xf bank_mask:0xf
  v_and_b32_dpp v17, v56, v5 row_newbcast:11 row_mask:0xf bank_mask:0xf
  v_and_b32_dpp v18, v56, v6 row_newbcast:11 row_mask:0xf bank_mask:0xf
  v_and_b32_dpp v19, v56, v7 row_newbcast:11 row_mask:0xf bank_mask:0xf
  s_waitcnt vmcnt(6)
  s_nop 0
  v_mfma_f32_16x16x32_bf16 v[24:27], v[16:19], v[140:143], v[24:27]
  v_and_b32_dpp v20, v56, v4 row_newbcast:12 row_mask:0xf bank_mask:0xf
  v_and_b32_dpp v21, v56, v5 row_newbcast:12 row_mask:0xf bank_mask:0xf
  v_and_b32_dpp v22, v56, v6 row_newbcast:12 row_mask:0xf bank_mask:0xf
  v_and_b32_dpp v23, v56, v7 row_newbcast:12 row_mask:0xf bank_mask:0xf
  s_waitcnt vmcnt(5)
  s_nop 0
  v_mfma_f32_16x16x32_bf16 v[24:27], v[20:23], v[144:147], v[24:27]
  v_and_b32_dpp v16, v56, v4 row_newbcast:13 row_mask:0xf bank_mask:0xf
  v_and_b32_dpp v17, v56, v5 row_newbcast:13 row_mask:0xf bank_mask:0xf
  v_and_b32_dpp v18, v56, v6 row_newbcast:13 row_mask:0xf bank_mask:0xf
  v_and_b32_dpp v19, v56, v7 row_newbcast:13 row_mask:0xf bank_mask:0xf
  s_waitcnt vmcnt(4)
  s_nop 0
  v_mfma_f32_16x16x32_bf16 v[24:27], v[16:19], v[148:151], v[24:27]
  v_and_b32_dpp v20, v56, v4 row_newbcast:14 row_mask:0xf bank_mask:0xf
  v_and_b32_dpp v21, v56, v5 row_newbcast:14 row_mask:0xf bank_mask:0xf
  v_and_b32_dpp v22, v56, v6 row_newbcast:14 row_mask:0xf bank_mask:0xf
  v_and_b32_dpp v23, v56, v7 row_newbcast:14 row_mask:0xf bank_mask:0xf
  s_waitcnt vmcnt(3)
  s_nop 0
  v_mfma_f32_16x16x32_bf16 v[24:27], v[20:23], v[152:155], v[24:27]
  v_and_b32_dpp v16, v56, v4 row_newbcast:15 row_mask:0xf bank_mask:0xf
  v_and_b32_dpp v17, v56, v5 row_newbcast:15 row_mask:0xf bank_mask:0xf
  v_and_b32_dpp v18, v56, v6 row_newbcast:15 row_mask:0xf bank_mask:0xf
  v_and_b32_dpp v19, v56, v7 row_newbcast:15 row_mask:0xf bank_mask:0xf
  s_waitcnt vmcnt(2)
  s_nop 0
  v_mfma_f32_16x16x32_bf16 v[24:27], v[16:19], v[156:159], v[24:27]
  v_and_b32_dpp v20, v57, v4 row_newbcast:0 row_mask:0xf bank_mask:0xf
  v_and_b32_dpp v21, v57, v5 row_newbcast:0 row_mask:0xf bank_mask:0xf
  v_and_b32_dpp v22, v57, v6 row_newbcast:0 row_mask:0xf bank_mask:0xf
  v_and_b32_dpp v23, v57, v7 row_newbcast:0 row_mask:0xf bank_mask:0xf
  s_waitcnt vmcnt(1)
  s_nop 0
  v_mfma_f32_16x16x32_bf16 v[24:27], v[20:23], v[160:163], v[24:27]
  v_and_b32_dpp v16, v57, v4 row_newbcast:1 row_mask:0xf bank_mask:0xf
  v_and_b32_dpp v17, v57, v5 row_newbcast:1 row_mask:0xf bank_mask:0xf
  v_and_b32_dpp v18, v57, v6 row_newbcast:1 row_mask:0xf bank_mask:0xf
  v_and_b32_dpp v19, v57, v7 row_newbcast:1 row_mask:0xf bank_mask:0xf
  s_waitcnt vmcnt(0)
  s_nop 0
  v_mfma_f32_16x16x32_bf16 v[24:27], v[16:19], v[164:167], v[24:27]
  v_lshlrev_b32 v8, 4, v1
  s_lshl_b32 s10, s6, 14
  s_add_u32 s10, s10, 9216
  s_lshl_b32 s11, s4, 17
  s_add_u32 s11, s11, 9216
  s_add_u32 s60, s11, 0
  s_add_u32 s61, s11, 16384
  s_add_u32 s62, s11, 32768
  s_add_u32 s63, s11, 49152
  s_add_u32 s64, s11, 65536
  s_add_u32 s65, s11, 81920
  s_add_u32 s66, s11, 98304
  s_add_u32 s67, s11, 114688
  v_mov_b32 v29, s75
  v_mov_b32 v31, s75
  v_mov_b32 v28, v24
  v_mov_b32 v30, v25
  s_nop 1
  v_permlane32_swap_b32 v28, v26
  v_permlane32_swap_b32 v30, v27
  s_mov_b64 s[44:45], 0
  s_cmp_lg_u32 s46, 0
  s_cbranch_scc1 L_q_wt
  s_mov_b64 exec, -1
  buffer_store_dwordx4 v[28:31], v8, s[52:55], s10 offen
  s_sleep 8
  buffer_load_dwordx4 v[96:99], v8, s[52:55], s60 offen nt
  buffer_load_dwordx4 v[100:103], v8, s[52:55], s61 offen nt
  buffer_load_dwordx4 v[104:107], v8, s[52:55], s62 offen nt
  buffer_load_dwordx4 v[108:111], v8, s[52:55], s63 offen nt
  buffer_load_dwordx4 v[112:115], v8, s[52:55], s64 offen nt
  buffer_load_dwordx4 v[116:119], v8, s[52:55], s65 offen nt
  buffer_load_dwordx4 v[120:123], v8, s[52:55], s66 offen nt
  buffer_load_dwordx4 v[124:127], v8, s[52:55], s67 offen nt
  s_waitcnt vmcnt(0)
  v_bitop3_b32 v9, v97, v99, s75 bitop3:0x7e
  v_bitop3_b32 v10, v101, v103, s75 bitop3:0x7e
  v_bitop3_b32 v15, v105, v107, s75 bitop3:0x7e
  v_or3_b32 v9, v9, v10, v15
  v_bitop3_b32 v10, v109, v111, s75 bitop3:0x7e
  v_bitop3_b32 v15, v113, v115, s75 bitop3:0x7e
  v_or3_b32 v9, v9, v10, v15
  v_bitop3_b32 v10, v117, v119, s75 bitop3:0x7e
  v_bitop3_b32 v15, v121, v123, s75 bitop3:0x7e
  v_or3_b32 v9, v9, v10, v15
  v_bitop3_b32 v10, v125, v127, s75 bitop3:0x7e
  v_or_b32 v9, v9, v10
  v_cmp_ne_u32 vcc, 0, v9
  s_or_b64 s[44:45], s[44:45], vcc
  v_cmp_lt_u32 vcc, 7, v9
  s_andn2_b64 s[44:45], s[44:45], vcc
  s_and_b64 exec, exec, vcc
  s_cbranch_execz L_q_chk
  s_cmp_lg_u64 s[44:45], 0
  s_cbranch_scc1 L_q_wt
  s_mov_b32 s14, 0
L_q_p1:
  buffer_load_dwordx4 v[96:99], v8, s[52:55], s60 offen sc1
  buffer_load_dwordx4 v[100:103], v8, s[52:55], s61 offen sc1
  buffer_load_dwordx4 v[104:107], v8, s[52:55], s62 offen sc1
  buffer_load_dwordx4 v[108:111], v8, s[52:55], s63 offen sc1
  buffer_load_dwordx4 v[112:115], v8, s[52:55], s64 offen sc1
  buffer_load_dwordx4 v[116:119], v8, s[52:55], s65 offen sc1
  buffer_load_dwordx4 v[120:123], v8, s[52:55], s66 offen sc1
  buffer_load_dwordx4 v[124:127], v8, s[52:55], s67 offen sc1
  s_waitcnt vmcnt(0)
  v_bitop3_b32 v9, v97, v99, s75 bitop3:0x7e
  v_bitop3_b32 v10, v101, v103, s75 bitop3:0x7e
  v_bitop3_b32 v15, v105, v107, s75 bitop3:0x7e
  v_or3_b32 v9, v9, v10, v15
  v_bitop3_b32 v10, v109, v111, s75 bitop3:0x7e
  v_bitop3_b32 v15, v113, v115, s75 bitop3:0x7e
  v_or3_b32 v9, v9, v10, v15
  v_bitop3_b32 v10, v117, v119, s75 bitop3:0x7e
  v_bitop3_b32 v15, v121, v123, s75 bitop3:0x7e
  v_or3_b32 v9, v9, v10, v15
  v_bitop3_b32 v10, v125, v127, s75 bitop3:0x7e
  v_or_b32 v9, v9, v10
  v_cmp_ne_u32 vcc, 0, v9
  s_or_b64 s[44:45], s[44:45], vcc
  v_cmp_lt_u32 vcc, 7, v9
  s_andn2_b64 s[44:45], s[44:45], vcc
  s_add_u32 s14, s14, 1
  s_and_b64 exec, exec, vcc
  s_cbranch_execz L_q_p1_done
  s_cmp_lg_u64 s[44:45], 0
  s_cbranch_scc1 L_q_wt
  s_sleep 16
  s_cmp_lt_u32 s14, 6
  s_cbranch_scc1 L_q_p1
L_q_p1_done:
L_q_chk:
  s_or_b64 s[44:45], s[44:45], exec
  s_cbranch_scc0 L_q_ok
L_q_wt:
  s_mov_b64 s[44:45], exec
  s_mov_b64 exec, -1
  buffer_store_dwordx4 v[28:31], v8, s[52:55], s10 offen sc1
  s_mov_b64 exec, s[44:45]
  s_cbranch_execz L_q_ok
  s_mov_b32 s14, 0
L_q_p2:
  buffer_load_dwordx4 v[96:99], v8, s[52:55], s60 offen sc1
  buffer_load_dwordx4 v[100:103], v8, s[52:55], s61 offen sc1
  buffer_load_dwordx4 v[104:107], v8, s[52:55], s62 offen sc1
  buffer_load_dwordx4 v[108:111], v8, s[52:55], s63 offen sc1
  buffer_load_dwordx4 v[112:115], v8, s[52:55], s64 offen sc1
  buffer_load_dwordx4 v[116:119], v8, s[52:55], s65 offen sc1
  buffer_load_dwordx4 v[120:123], v8, s[52:55], s66 offen sc1
  buffer_load_dwordx4 v[124:127], v8, s[52:55], s67 offen sc1
  s_waitcnt vmcnt(0)
  v_bitop3_b32 v9, v97, v99, s75 bitop3:0x7e
  v_bitop3_b32 v10, v101, v103, s75 bitop3:0x7e
  v_bitop3_b32 v15, v105, v107, s75 bitop3:0x7e
  v_or3_b32 v9, v9, v10, v15
  v_bitop3_b32 v10, v109, v111, s75 bitop3:0x7e
  v_bitop3_b32 v15, v113, v115, s75 bitop3:0x7e
  v_or3_b32 v9, v9, v10, v15
  v_bitop3_b32 v10, v117, v119, s75 bitop3:0x7e
  v_bitop3_b32 v15, v121, v123, s75 bitop3:0x7e
  v_or3_b32 v9, v9, v10, v15
  v_bitop3_b32 v10, v125, v127, s75 bitop3:0x7e
  v_or_b32 v9, v9, v10
  v_cmp_ne_u32 vcc, 0, v9
  s_or_b64 s[44:45], s[44:45], vcc
  v_cmp_lt_u32 vcc, 7, v9
  s_andn2_b64 s[44:45], s[44:45], vcc
  s_add_u32 s14, s14, 1
  s_and_b64 exec, exec, vcc
  s_cbranch_execz L_q_p2_done
  s_sleep 16
  s_cmp_lt_u32 s14, 262144
  s_cbranch_scc1 L_q_p2
L_q_p2_done:
  s_mov_b64 exec, -1
L_q_ok:
  s_mov_b64 exec, -1
  v_add_f32 v96, v96, v100
  v_add_f32 v104, v104, v108
  v_add_f32 v112, v112, v116
  v_add_f32 v120, v120, v124
  v_add_f32 v96, v96, v104
  v_add_f32 v112, v112, v120
  v_add_f32 v28, v96, v112
  v_add_f32 v98, v98, v102
  v_add_f32 v106, v106, v110
  v_add_f32 v114, v114, v118
  v_add_f32 v122, v122, v126
  v_add_f32 v98, v98, v106
  v_add_f32 v114, v114, v122
  v_add_f32 v29, v98, v114
  v_lshlrev_b32 v8, 5, v3
  v_and_b32 v9, 1, v2
  v_lshl_add_u32 v8, v9, 4, v8
  v_lshrrev_b32 v9, 1, v2
  v_lshl_add_u32 v8, v9, 3, v8
  ds_write_b64 v8, v[28:29] offset:0
  v_mov_b32 v9, 512
  v_mov_b32 v10, 0
  ds_write_b32 v9, v10
  ds_write_b32 v9, v10 offset:4
  ds_write_b32 v9, v10 offset:12
  s_add_u32 s79, s78, 0x40000000
  v_mov_b32 v11, s79
  ds_write_b32 v9, v11 offset:8
  ds_write_b32 v9, v10 offset:20
  v_mov_b32 v11, -1.0
  ds_write_b32 v10, v11 offset:1028
  ds_write_b32 v10, v11 offset:1036
  ds_write_b32 v10, v11 offset:1044
  ds_write_b32 v10, v11 offset:1052
  s_waitcnt lgkmcnt(0)
  s_barrier
L_noq:
  buffer_load_dwordx4 v[168:171], v60, s[56:59], s8 offen nt
  buffer_load_dwordx4 v[172:175], v61, s[56:59], s8 offen nt
  s_add_u32 s8, s8, 36864
  buffer_load_dwordx4 v[176:179], v60, s[56:59], s8 offen nt
  buffer_load_dwordx4 v[180:183], v61, s[56:59], s8 offen nt
  s_add_u32 s8, s8, 36864
  buffer_load_dwordx4 v[184:187], v60, s[56:59], s8 offen nt
  buffer_load_dwordx4 v[188:191], v61, s[56:59], s8 offen nt
  s_add_u32 s8, s8, 36864
  buffer_load_dwordx4 v[192:195], v60, s[56:59], s8 offen nt
  buffer_load_dwordx4 v[196:199], v61, s[56:59], s8 offen nt
  s_add_u32 s8, s8, 36864
  buffer_load_dwordx4 v[200:203], v60, s[56:59], s8 offen nt
  buffer_load_dwordx4 v[204:207], v61, s[56:59], s8 offen nt
  s_add_u32 s8, s8, 36864
  v_lshlrev_b32 v8, 5, v3
  v_lshl_add_u32 v8, v2, 4, v8
  s_mul_i32 s10, s7, 576
  v_add_u32 v66, s10, v8
  s_mul_i32 s10, s7, 2304
  v_add_u32 v67, s10, v8
  v_and_b32_dpp v20, v58, v4 row_newbcast:0 row_mask:0xf bank_mask:0xf
  v_and_b32_dpp v21, v58, v5 row_newbcast:0 row_mask:0xf bank_mask:0xf
  v_and_b32_dpp v22, v58, v6 row_newbcast:0 row_mask:0xf bank_mask:0xf
  v_and_b32_dpp v23, v58, v7 row_newbcast:0 row_mask:0xf bank_mask:0xf
  s_waitcnt vmcnt(8)
  s_nop 0
  v_mfma_f32_16x16x32_bf16 v[24:27], v[20:23], v[168:171], 0
  v_mfma_f32_16x16x32_bf16 v[28:31], v[20:23], v[172:175], 0
  buffer_load_dwordx4 v[208:211], v60, s[56:59], s8 offen nt
  buffer_load_dwordx4 v[212:215], v61, s[56:59], s8 offen nt
  s_add_u32 s8, s8, 36864
  v_and_b32_dpp v16, v58, v4 row_newbcast:1 row_mask:0xf bank_mask:0xf
  v_and_b32_dpp v17, v58, v5 row_newbcast:1 row_mask:0xf bank_mask:0xf
  v_and_b32_dpp v18, v58, v6 row_newbcast:1 row_mask:0xf bank_mask:0xf
  v_and_b32_dpp v19, v58, v7 row_newbcast:1 row_mask:0xf bank_mask:0xf
  s_waitcnt vmcnt(8)
  s_nop 0
  v_mfma_f32_16x16x32_bf16 v[24:27], v[16:19], v[176:179], v[24:27]
  v_mfma_f32_16x16x32_bf16 v[28:31], v[16:19], v[180:183], v[28:31]
  buffer_load_dwordx4 v[216:219], v60, s[56:59], s8 offen nt
  buffer_load_dwordx4 v[220:223], v61, s[56:59], s8 offen nt
  s_add_u32 s8, s8, 36864
  v_and_b32_dpp v20, v58, v4 row_newbcast:2 row_mask:0xf bank_mask:0xf
  v_and_b32_dpp v21, v58, v5 row_newbcast:2 row_mask:0xf bank_mask:0xf
  v_and_b32_dpp v22, v58, v6 row_newbcast:2 row_mask:0xf bank_mask:0xf
  v_and_b32_dpp v23, v58, v7 row_newbcast:2 row_mask:0xf bank_mask:0xf
  s_waitcnt vmcnt(8)
  s_nop 0
  v_mfma_f32_16x16x32_bf16 v[24:27], v[20:23], v[184:187], v[24:27]
  v_mfma_f32_16x16x32_bf16 v[28:31], v[20:23], v[188:191], v[28:31]
  buffer_load_dwordx4 v[224:227], v60, s[56:59], s8 offen nt
  buffer_load_dwordx4 v[228:231], v61, s[56:59], s8 offen nt
  s_add_u32 s8, s8, 36864
  v_and_b32_dpp v16, v58, v4 row_newbcast:3 row_mask:0xf bank_mask:0xf
  v_and_b32_dpp v17, v58, v5 row_newbcast:3 row_mask:0xf bank_mask:0xf
  v_and_b32_dpp v18, v58, v6 row_newbcast:3 row_mask:0xf bank_mask:0xf
  v_and_b32_dpp v19, v58, v7 row_newbcast:3 row_mask:0xf bank_mask:0xf
  s_waitcnt vmcnt(8)
  s_nop 0
  v_mfma_f32_16x16x32_bf16 v[24:27], v[16:19], v[192:195], v[24:27]
  v_mfma_f32_16x16x32_bf16 v[28:31], v[16:19], v[196:199], v[28:31]
  buffer_load_dwordx4 v[232:235], v60, s[56:59], s8 offen nt
  buffer_load_dwordx4 v[236:239], v61, s[56:59], s8 offen nt
  s_add_u32 s8, s8, 36864
  v_and_b32_dpp v20, v58, v4 row_newbcast:4 row_mask:0xf bank_mask:0xf
  v_and_b32_dpp v21, v58, v5 row_newbcast:4 row_mask:0xf bank_mask:0xf
  v_and_b32_dpp v22, v58, v6 row_newbcast:4 row_mask:0xf bank_mask:0xf
  v_and_b32_dpp v23, v58, v7 row_newbcast:4 row_mask:0xf bank_mask:0xf
  s_waitcnt vmcnt(8)
  s_nop 0
  v_mfma_f32_16x16x32_bf16 v[24:27], v[20:23], v[200:203], v[24:27]
  v_mfma_f32_16x16x32_bf16 v[28:31], v[20:23], v[204:207], v[28:31]
  v_and_b32_dpp v16, v58, v4 row_newbcast:5 row_mask:0xf bank_mask:0xf
  v_and_b32_dpp v17, v58, v5 row_newbcast:5 row_mask:0xf bank_mask:0xf
  v_and_b32_dpp v18, v58, v6 row_newbcast:5 row_mask:0xf bank_mask:0xf
  v_and_b32_dpp v19, v58, v7 row_newbcast:5 row_mask:0xf bank_mask:0xf
  s_waitcnt vmcnt(6)
  s_nop 0
  v_mfma_f32_16x16x32_bf16 v[24:27], v[16:19], v[208:211], v[24:27]
  v_mfma_f32_16x16x32_bf16 v[28:31], v[16:19], v[212:215], v[28:31]
  v_and_b32_dpp v20, v58, v4 row_newbcast:6 row_mask:0xf bank_mask:0xf
  v_and_b32_dpp v21, v58, v5 row_newbcast:6 row_mask:0xf bank_mask:0xf
  v_and_b32_dpp v22, v58, v6 row_newbcast:6 row_mask:0xf bank_mask:0xf
  v_and_b32_dpp v23, v58, v7 row_newbcast:6 row_mask:0xf bank_mask:0xf
  s_waitcnt vmcnt(4)
  s_nop 0
  v_mfma_f32_16x16x32_bf16 v[24:27], v[20:23], v[216:219], v[24:27]
  v_mfma_f32_16x16x32_bf16 v[28:31], v[20:23], v[220:223], v[28:31]
  v_and_b32_dpp v16, v58, v4 row_newbcast:7 row_mask:0xf bank_mask:0xf
  v_and_b32_dpp v17, v58, v5 row_newbcast:7 row_mask:0xf bank_mask:0xf
  v_and_b32_dpp v18, v58, v6 row_newbcast:7 row_mask:0xf bank_mask:0xf
  v_and_b32_dpp v19, v58, v7 row_newbcast:7 row_mask:0xf bank_mask:0xf
  s_waitcnt vmcnt(2)
  s_nop 0
  v_mfma_f32_16x16x32_bf16 v[24:27], v[16:19], v[224:227], v[24:27]
  v_mfma_f32_16x16x32_bf16 v[28:31], v[16:19], v[228:231], v[28:31]
  v_and_b32_dpp v20, v58, v4 row_newbcast:8 row_mask:0xf bank_mask:0xf
  v_and_b32_dpp v21, v58, v5 row_newbcast:8 row_mask:0xf bank_mask:0xf
  v_and_b32_dpp v22, v58, v6 row_newbcast:8 row_mask:0xf bank_mask:0xf
  v_and_b32_dpp v23, v58, v7 row_newbcast:8 row_mask:0xf bank_mask:0xf
  s_waitcnt vmcnt(0)
  s_nop 0
  v_mfma_f32_16x16x32_bf16 v[24:27], v[20:23], v[232:235], v[24:27]
  v_mfma_f32_16x16x32_bf16 v[28:31], v[20:23], v[236:239], v[28:31]
  s_mul_i32 s10, s5, 36864
  s_mul_i32 s11, s4, 1152
  s_add_u32 s10, s10, s11
  s_add_u32 s68, s10, 4194304
  s_nop 3
  s_mov_b32 exec_hi, 0
  ds_write_b128 v66, v[24:27] offset:3328
  s_mov_b32 exec_lo, 0x00030003
  ds_write_b128 v66, v[28:31] offset:3840
  s_mov_b64 exec, -1
  s_cmp_eq_u32 s7, 0
  s_cbranch_scc1 L_b1done
  s_barrier
L_b1done:
  v_mov_b32 v8, 512
  v_mov_b32 v9, 1
  s_mov_b64 exec, 1
  s_waitcnt lgkmcnt(0)
  ds_add_u32 v8, v9 offset:12
  s_mov_b64 exec, -1
  s_mov_b32 s48, s24
  s_mov_b32 s49, s25
  s_mov_b32 s50, 4718592
  s_mov_b32 s51, 0x20000
  v_mul_u32_u24 v8, 1152, v2
  v_lshl_add_u32 v60, v3, 4, v8
  v_mov_b32 v9, 1073741824
  v_cmp_gt_u32 vcc, 8, v3
  s_lshl_b32 s10, s4, 2
  s_add_u32 s10, s10, s7
  v_cndmask_b32 v61, v9, v60, vcc
  s_mul_i32 s8, s10, 36864
  s_waitcnt vmcnt(2)
  buffer_load_dwordx4 v[96:99], v60, s[48:51], s8 offen offset:0 nt
  s_waitcnt vmcnt(2)
  buffer_load_dwordx4 v[100:103], v60, s[48:51], s8 offen offset:256 nt
  s_waitcnt vmcnt(2)
  buffer_load_dwordx4 v[104:107], v60, s[48:51], s8 offen offset:512 nt
  s_waitcnt vmcnt(2)
  buffer_load_dwordx4 v[108:111], v60, s[48:51], s8 offen offset:768 nt
  s_waitcnt vmcnt(2)
  buffer_load_dwordx4 v[112:115], v61, s[48:51], s8 offen offset:1024 nt
  s_add_u32 s8, s8, 4608
  s_waitcnt vmcnt(2)
  buffer_load_dwordx4 v[116:119], v60, s[48:51], s8 offen offset:0 nt
  s_waitcnt vmcnt(2)
  buffer_load_dwordx4 v[120:123], v60, s[48:51], s8 offen offset:256 nt
  s_waitcnt vmcnt(2)
  buffer_load_dwordx4 v[124:127], v60, s[48:51], s8 offen offset:512 nt
  s_waitcnt vmcnt(2)
  buffer_load_dwordx4 v[128:131], v60, s[48:51], s8 offen offset:768 nt
  s_waitcnt vmcnt(2)
  buffer_load_dwordx4 v[132:135], v61, s[48:51], s8 offen offset:1024 nt
  s_add_u32 s8, s8, 4608
  s_waitcnt vmcnt(2)
  buffer_load_dwordx4 v[136:139], v60, s[48:51], s8 offen offset:0 nt
  s_waitcnt vmcnt(2)
  buffer_load_dwordx4 v[140:143], v60, s[48:51], s8 offen offset:256 nt
  s_waitcnt vmcnt(2)
  buffer_load_dwordx4 v[144:147], v60, s[48:51], s8 offen offset:512 nt
  s_waitcnt vmcnt(2)
  buffer_load_dwordx4 v[148:151], v60, s[48:51], s8 offen offset:768 nt
  s_waitcnt vmcnt(2)
  buffer_load_dwordx4 v[152:155], v61, s[48:51], s8 offen offset:1024 nt
  s_add_u32 s8, s8, 4608
  s_waitcnt vmcnt(2)
  buffer_load_dwordx4 v[156:159], v60, s[48:51], s8 offen offset:0 nt
  s_waitcnt vmcnt(2)
  buffer_load_dwordx4 v[160:163], v60, s[48:51], s8 offen offset:256 nt
  s_waitcnt vmcnt(2)
  buffer_load_dwordx4 v[164:167], v60, s[48:51], s8 offen offset:512 nt
  s_waitcnt vmcnt(2)
  buffer_load_dwordx4 v[168:171], v60, s[48:51], s8 offen offset:768 nt
  s_waitcnt vmcnt(2)
  buffer_load_dwordx4 v[172:175], v61, s[48:51], s8 offen offset:1024 nt
  s_add_u32 s8, s8, 4608
  s_waitcnt vmcnt(2)
  buffer_load_dwordx4 v[176:179], v60, s[48:51], s8 offen offset:0 nt
  s_waitcnt vmcnt(2)
  buffer_load_dwordx4 v[180:183], v60, s[48:51], s8 offen offset:256 nt
  s_waitcnt vmcnt(2)
  buffer_load_dwordx4 v[184:187], v60, s[48:51], s8 offen offset:512 nt
  s_waitcnt vmcnt(2)
  buffer_load_dwordx4 v[188:191], v60, s[48:51], s8 offen offset:768 nt
  s_waitcnt vmcnt(2)
  buffer_load_dwordx4 v[192:195], v61, s[48:51], s8 offen offset:1024 nt
  s_add_u32 s8, s8, 4608
  s_waitcnt vmcnt(2)
  buffer_load_dwordx4 v[196:199], v60, s[48:51], s8 offen offset:0 nt
  s_waitcnt vmcnt(2)
  buffer_load_dwordx4 v[200:203], v60, s[48:51], s8 offen offset:256 nt
  s_waitcnt vmcnt(2)
  buffer_load_dwordx4 v[204:207], v60, s[48:51], s8 offen offset:512 nt
  s_waitcnt vmcnt(2)
  buffer_load_dwordx4 v[208:211], v60, s[48:51], s8 offen offset:768 nt
  s_waitcnt vmcnt(2)
  buffer_load_dwordx4 v[212:215], v61, s[48:51], s8 offen offset:1024 nt
  s_add_u32 s8, s8, 4608
  s_waitcnt vmcnt(2)
  buffer_load_dwordx4 v[216:219], v60, s[48:51], s8 offen offset:0 nt
  s_waitcnt vmcnt(2)
  buffer_load_dwordx4 v[220:223], v60, s[48:51], s8 offen offset:256 nt
  s_waitcnt vmcnt(2)
  buffer_load_dwordx4 v[224:227], v60, s[48:51], s8 offen offset:512 nt
  s_waitcnt vmcnt(2)
  buffer_load_dwordx4 v[228:231], v60, s[48:51], s8 offen offset:768 nt
  s_waitcnt vmcnt(2)
  buffer_load_dwordx4 v[232:235], v61, s[48:51], s8 offen offset:1024 nt
  s_add_u32 s8, s8, 4608
  s_waitcnt vmcnt(2)
  buffer_load_dwordx4 v[236:239], v60, s[48:51], s8 offen offset:0 nt
  s_waitcnt vmcnt(2)
  buffer_load_dwordx4 v[240:243], v60, s[48:51], s8 offen offset:256 nt
  s_waitcnt vmcnt(2)
  buffer_load_dwordx4 v[244:247], v60, s[48:51], s8 offen offset:512 nt
  s_waitcnt vmcnt(2)
  buffer_load_dwordx4 v[248:251], v60, s[48:51], s8 offen offset:768 nt
  s_waitcnt vmcnt(2)
  buffer_load_dwordx4 v[252:255], v61, s[48:51], s8 offen offset:1024 nt
  s_add_u32 s8, s8, 4608
  v_and_b32 v8, 7, v3
  v_lshl_add_u32 v8, v8, 2, v2
  s_lshl_b32 s10, s7, 7
  v_lshl_add_u32 v66, v8, 2, s10
  v_and_b32 v8, 1, v1
  v_lshrrev_b32 v9, 2, v1
  v_lshlrev_b32 v9, 4, v9
  v_lshl_add_u32 v8, v8, 3, v9
  s_lshl_b32 s10, s3, 8
  v_add_u32 v68, s10, v8
  v_lshlrev_b32 v69, 4, v1
  v_and_b32 v8, 2, v1
  v_cmp_eq_u32 s[62:63], 0, v8
  v_mov_b32 v71, 512
  v_mov_b32 v72, 1
  v_mov_b32 v41, s15
  v_mov_b32 v43, s15
  s_lshl_b32 s60, s6, 14
  s_lshl_b32 s10, s3, 10
  s_add_u32 s60, s60, s10
  v_mov_b32 v70, 0
  v_lshlrev_b32 v65, 13, v1
  v_mov_b32 v81, s15
  v_mov_b32 v83, s15
  s_lshl_b32 s9, s6, 5
  s_add_u32 s9, s9, 5373952
  s_mov_b32 s12, 1069066811
  s_cmp_lg_u32 s7, 3
  s_cbranch_scc1 L_nocal
  s_and_b32 s64, s2, 0
  s_lshl_b32 s64, s64, 7
  v_lshrrev_b32 v8, 3, v1
  v_mul_u32_u24 v8, 128, v8
  v_and_b32 v9, 7, v1
  v_add3_u32 v8, v8, v9, 64
  v_lshlrev_b32 v44, 7, v8
  v_mov_b32 v93, s15
  v_mov_b32 v95, s15
  v_mul_u32_u24 v8, 57, v1
  v_lshrrev_b32 v8, 9, v8
  v_mul_u32_u24 v9, 9, v8
  v_sub_u32 v9, v1, v9
  v_mul_u32_u24 v11, 36864, v8
  v_lshl_add_u32 v11, v9, 4, v11
  s_mul_i32 s10, s6, 144
  s_add_u32 s10, s10, 4194304
  v_add_u32 v11, s10, v11
  v_mul_u32_u24 v12, 72, v8
  v_lshl_add_u32 v12, v9, 3, v12
  v_add_u32 v12, 17920, v12
  v_mov_b32 v13, 1073741824
  v_cmp_gt_u32 s[70:71], 1, v8
  v_lshl_add_u32 v75, v3, 2, v2
  v_cmp_gt_u32 s[72:73], 18, v75
  v_lshlrev_b32 v75, 2, v75
  v_cndmask_b32 v13, v13, v11, s[70:71]
  v_lshlrev_b32 v76, 2, v1
  s_mov_b32 s14, 0
L_cw67:
  s_sleep 4
  ds_read_b64 v[8:9], v71 offset:16
  s_add_u32 s14, s14, 1
  s_waitcnt lgkmcnt(0)
  v_readfirstlane_b32 s67, v9
  s_cmp_ge_u32 s14, 262144
  s_cbranch_scc1 L_cw67x
  s_cmp_lt_u32 s67, 3
  s_cbranch_scc1 L_cw67
L_cw67x:
  s_and_b32 s10, s2, 120
  s_cmp_lg_u32 s10, 64
  s_cbranch_scc1 L_cs68
  ds_read_b32 v92, v71 offset:40
  s_waitcnt lgkmcnt(0)
  v_mov_b32 v94, v92
  s_lshl_b32 s10, s2, 7
  s_add_u32 s10, s10, 5902336
  s_mov_b64 exec, 0xff
  buffer_store_dwordx4 v[92:95], v69, s[52:55], s10 offen sc1
  s_mov_b64 exec, -1
L_cs68:
  s_mov_b32 s14, 0
L_cw69:
  s_sleep 4
  ds_read_b64 v[8:9], v71 offset:16
  s_add_u32 s14, s14, 1
  s_waitcnt lgkmcnt(0)
  v_readfirstlane_b32 s67, v9
  s_cmp_ge_u32 s14, 262144
  s_cbranch_scc1 L_cw69x
  s_cmp_lt_u32 s67, 4
  s_cbranch_scc1 L_cw69
L_cw69x:
  s_add_u32 s10, s64, 5902336
  v_mov_b32 v79, 0
  v_mov_b32 v78, 0
  s_mov_b64 exec, 65535
  buffer_load_dwordx2 v[78:79], v44, s[52:55], s10 offen
  s_mov_b64 exec, -1
  s_waitcnt vmcnt(0)
  v_cmp_eq_u32 vcc, s15, v79
  v_sub_u32 v78, v78, v8
  v_cvt_f32_i32 v78, v78
  s_bcnt1_i32_b64 s65, vcc
  v_cndmask_b32 v78, 0, v78, vcc
  s_nop 1
  v_add_f32_dpp v78, v78, v78 row_shr:1 row_mask:0xf bank_mask:0xf
  s_nop 1
  v_add_f32_dpp v78, v78, v78 row_shr:2 row_mask:0xf bank_mask:0xf
  s_nop 1
  v_add_f32_dpp v78, v78, v78 row_shr:4 row_mask:0xf bank_mask:0xf
  s_nop 1
  v_add_f32_dpp v78, v78, v78 row_shr:8 row_mask:0xf bank_mask:0xf
  s_nop 1
  v_add_f32_dpp v78, v78, v78 row_bcast:15 row_mask:0xa bank_mask:0xf
  s_nop 1
  v_add_f32_dpp v78, v78, v78 row_bcast:31 row_mask:0xc bank_mask:0xf
  s_nop 1
  s_cmp_lt_u32 s65, 8
  s_cbranch_scc1 L_cf70
  v_cvt_f32_u32 v9, s65
  v_rcp_f32 v9, v9
  s_nop 0
  v_mul_f32 v78, v78, v9
  v_cvt_i32_f32 v78, v78
  v_add_u32 v78, v78, v8
  v_subrev_u32 v78, 914, v78
  s_mov_b32 exec_lo, 0
  s_mov_b32 exec_hi, 0x80000000
  ds_write_b32 v71, v78 offset:8
  s_mov_b64 exec, -1
L_cf70:
  s_mov_b32 s14, 0
L_cw71:
  s_sleep 4
  ds_read_b64 v[8:9], v71 offset:16
  ds_read_b32 v10, v71 offset:12
  s_add_u32 s14, s14, 1
  s_waitcnt lgkmcnt(0)
  v_readfirstlane_b32 s67, v9
  v_readfirstlane_b32 s66, v10
  s_cmp_ge_u32 s14, 262144
  s_cbranch_scc1 L_cw71x
  s_cmp_lt_u32 s67, 5
  s_cbranch_scc1 L_cw71
  s_cmp_lt_u32 s66, 4
  s_cbranch_scc1 L_cw71
L_cw71x:
  s_and_b32 s10, s2, 120
  s_cmp_lg_u32 s10, 64
  s_cbranch_scc1 L_cs72
  ds_read_b32 v92, v71 offset:48
  s_waitcnt lgkmcnt(0)
  v_mov_b32 v94, v92
  s_lshl_b32 s10, s2, 7
  s_add_u32 s10, s10, 5935104
  s_mov_b64 exec, 0xff
  buffer_store_dwordx4 v[92:95], v69, s[52:55], s10 offen sc1
  s_mov_b64 exec, -1
L_cs72:
  v_lshlrev_b32 v8, 3, v1
  ds_read_b64 v[24:25], v8 offset:3328
  ds_read_b64 v[32:33], v8 offset:3840
  ds_read_b64 v[26:27], v8 offset:3904
  ds_read_b64 v[34:35], v8 offset:4416
  ds_read_b64 v[28:29], v8 offset:4480
  ds_read_b64 v[36:37], v8 offset:4992
  ds_read_b64 v[30:31], v8 offset:5056
  ds_read_b64 v[38:39], v8 offset:5568
  v_mov_b32 v49, s75
  v_mov_b32 v51, s75
  v_mov_b32 v53, s75
  v_mov_b32 v55, s75
  s_waitcnt lgkmcnt(0)
  v_add_f32 v24, v24, v26
  v_add_f32 v28, v28, v30
  v_add_f32 v48, v24, v28
  v_add_f32 v25, v25, v27
  v_add_f32 v29, v29, v31
  v_add_f32 v50, v25, v29
  v_add_f32 v32, v32, v34
  v_add_f32 v36, v36, v38
  v_add_f32 v52, v32, v36
  v_add_f32 v33, v33, v35
  v_add_f32 v37, v37, v39
  v_add_f32 v54, v33, v37
  s_cmp_lg_u32 s46, 0
  s_cbranch_scc1 L_gu_wt
  s_mov_b64 exec, -1
  buffer_store_dwordx4 v[48:51], v69, s[52:55], s68 offen
  s_mov_b64 exec, 0xff
  buffer_store_dwordx4 v[52:55], v69, s[52:55], s68 offen offset:1024
  s_mov_b64 exec, -1
  s_branch L_gu_pub
L_gu_wt:
  s_mov_b64 exec, -1
  buffer_store_dwordx4 v[48:51], v69, s[52:55], s68 offen sc1
  s_mov_b64 exec, 0xff
  buffer_store_dwordx4 v[52:55], v69, s[52:55], s68 offen offset:1024 sc1
  s_mov_b64 exec, -1
L_gu_pub:
  s_mov_b32 s14, 0
L_cw73:
  s_sleep 4
  ds_read_b64 v[8:9], v71 offset:16
  s_add_u32 s14, s14, 1
  s_waitcnt lgkmcnt(0)
  v_readfirstlane_b32 s67, v9
  s_cmp_ge_u32 s14, 262144
  s_cbranch_scc1 L_cw73x
  s_cmp_lt_u32 s67, 6
  s_cbranch_scc1 L_cw73
L_cw73x:
  s_add_u32 s10, s64, 5935104
  v_mov_b32 v79, 0
  v_mov_b32 v78, 0
  s_mov_b64 exec, 65535
  buffer_load_dwordx2 v[78:79], v44, s[52:55], s10 offen
  s_mov_b32 exec_lo, -1
  s_mov_b32 exec_hi, 0x7fffffff
  s_mov_b32 s10, 258048
  buffer_load_dwordx4 v[24:27], v11, s[52:55], 0 offen nt
  buffer_load_dwordx4 v[28:31], v13, s[52:55], s10 offen nt
  s_mov_b64 exec, -1
  s_waitcnt vmcnt(2)
  v_cmp_eq_u32 vcc, s15, v79
  v_sub_u32 v78, v78, v8
  v_cvt_f32_i32 v78, v78
  s_bcnt1_i32_b64 s65, vcc
  v_cndmask_b32 v78, 0, v78, vcc
  s_nop 1
  v_add_f32_dpp v78, v78, v78 row_shr:1 row_mask:0xf bank_mask:0xf
  s_nop 1
  v_add_f32_dpp v78, v78, v78 row_shr:2 row_mask:0xf bank_mask:0xf
  s_nop 1
  v_add_f32_dpp v78, v78, v78 row_shr:4 row_mask:0xf bank_mask:0xf
  s_nop 1
  v_add_f32_dpp v78, v78, v78 row_shr:8 row_mask:0xf bank_mask:0xf
  s_nop 1
  v_add_f32_dpp v78, v78, v78 row_bcast:15 row_mask:0xa bank_mask:0xf
  s_nop 1
  v_add_f32_dpp v78, v78, v78 row_bcast:31 row_mask:0xc bank_mask:0xf
  s_nop 1
  s_cmp_lt_u32 s65, 8
  s_cbranch_scc1 L_cf74
  v_cvt_f32_u32 v9, s65
  v_rcp_f32 v9, v9
  s_nop 0
  v_mul_f32 v78, v78, v9
  v_cvt_i32_f32 v78, v78
  v_add_u32 v78, v78, v8
  v_subrev_u32 v78, 1858, v78
  s_mov_b32 exec_lo, 0
  s_mov_b32 exec_hi, 0x80000000
  ds_write_b32 v71, v78 offset:8
  s_mov_b64 exec, -1
L_cf74:
  s_mov_b32 exec_hi, 0x7fffffff
  s_mov_b64 s[44:45], 0
  s_waitcnt vmcnt(0)
  v_mov_b32 v14, s75
  v_cndmask_b32 v29, v14, v29, s[70:71]
  v_cndmask_b32 v31, v14, v31, s[70:71]
  v_bitop3_b32 v9, v25, v27, s75 bitop3:0x7e
  v_bitop3_b32 v10, v29, v31, s75 bitop3:0x7e
  v_or_b32 v9, v9, v10
  v_cmp_ne_u32 vcc, 0, v9
  s_or_b64 s[44:45], s[44:45], vcc
  v_cmp_lt_u32 vcc, 7, v9
  s_andn2_b64 s[44:45], s[44:45], vcc
  s_and_b64 exec, exec, vcc
  s_cbranch_execz L_h_chk
  s_cmp_lg_u64 s[44:45], 0
  s_cbranch_scc1 L_h_wt
  s_mov_b32 s14, 0
L_h_p1:
  s_mov_b32 s10, 258048
  buffer_load_dwordx4 v[24:27], v11, s[52:55], 0 offen sc1
  buffer_load_dwordx4 v[28:31], v13, s[52:55], s10 offen sc1
  s_waitcnt vmcnt(0)
  v_mov_b32 v14, s75
  v_cndmask_b32 v29, v14, v29, s[70:71]
  v_cndmask_b32 v31, v14, v31, s[70:71]
  v_bitop3_b32 v9, v25, v27, s75 bitop3:0x7e
  v_bitop3_b32 v10, v29, v31, s75 bitop3:0x7e
  v_or_b32 v9, v9, v10
  v_cmp_ne_u32 vcc, 0, v9
  s_or_b64 s[44:45], s[44:45], vcc
  v_cmp_lt_u32 vcc, 7, v9
  s_andn2_b64 s[44:45], s[44:45], vcc
  s_add_u32 s14, s14, 1
  s_and_b64 exec, exec, vcc
  s_cbranch_execz L_h_p1_done
  s_cmp_lg_u64 s[44:45], 0
  s_cbranch_scc1 L_h_wt
  s_sleep 40
  s_cmp_lt_u32 s14, 4
  s_cbranch_scc1 L_h_p1
L_h_p1_done:
L_h_chk:
  s_or_b64 s[44:45], s[44:45], exec
  s_cbranch_scc0 L_h_ok
L_h_wt:
  s_mov_b64 s[44:45], exec
  s_mov_b64 exec, -1
  buffer_store_dwordx4 v[48:51], v69, s[52:55], s68 offen sc1
  s_mov_b64 exec, 0xff
  buffer_store_dwordx4 v[52:55], v69, s[52:55], s68 offen offset:1024 sc1
  s_mov_b64 exec, -1
  s_mov_b64 exec, s[44:45]
  s_cbranch_execz L_h_ok
  s_mov_b32 s14, 0
L_h_p2:
  s_mov_b32 s10, 258048
  buffer_load_dwordx4 v[24:27], v11, s[52:55], 0 offen sc1
  buffer_load_dwordx4 v[28:31], v13, s[52:55], s10 offen sc1
  s_waitcnt vmcnt(0)
  v_mov_b32 v14, s75
  v_cndmask_b32 v29, v14, v29, s[70:71]
  v_cndmask_b32 v31, v14, v31, s[70:71]
  v_bitop3_b32 v9, v25, v27, s75 bitop3:0x7e
  v_bitop3_b32 v10, v29, v31, s75 bitop3:0x7e
  v_or_b32 v9, v9, v10
  v_cmp_ne_u32 vcc, 0, v9
  s_or_b64 s[44:45], s[44:45], vcc
  v_cmp_lt_u32 vcc, 7, v9
  s_andn2_b64 s[44:45], s[44:45], vcc
  s_add_u32 s14, s14, 1
  s_and_b64 exec, exec, vcc
  s_cbranch_execz L_h_p2_done
  s_sleep 40
  s_cmp_lt_u32 s14, 262144
  s_cbranch_scc1 L_h_p2
L_h_p2_done:
  s_mov_b64 exec, -1
L_h_ok:
  s_mov_b64 exec, -1
  s_mov_b32 exec_lo, -1
  s_mov_b32 exec_hi, 0x7fffffff
  ds_write2_b32 v12, v24, v26 offset0:0 offset1:1
  s_mov_b64 exec, s[70:71]
  ds_write2_b32 v12, v28, v30 offset0:126 offset1:127
  s_mov_b64 exec, -1
  s_waitcnt lgkmcnt(0)
  ds_read_b32 v24, v75 offset:17920
  ds_read_b32 v25, v75 offset:17992
  ds_read_b32 v26, v75 offset:18064
  ds_read_b32 v27, v75 offset:18136
  ds_read_b32 v28, v75 offset:18208
  ds_read_b32 v29, v75 offset:18280
  ds_read_b32 v30, v75 offset:18352
  ds_read_b32 v31, v75 offset:18424
  s_waitcnt lgkmcnt(0)
  v_add_f32 v24, v24, v25
  v_add_f32 v26, v26, v27
  v_add_f32 v88, v24, v26
  v_add_f32 v28, v28, v29
  v_add_f32 v30, v30, v31
  v_add_f32 v89, v28, v30
  v_cvt_pk_bf16_f32 v88, v88, v88
  v_lshlrev_b32 v88, 16, v88
  v_cvt_pk_bf16_f32 v89, v89, v89
  v_lshlrev_b32 v89, 16, v89
  v_mul_f32 v64, v88, v89
  v_cvt_pk_bf16_f32 v64, v64, v64
  v_cndmask_b32 v64, 0, v64, s[72:73]
  ds_write_b32 v76, v64 offset:768
L_nocal:
  s_waitcnt vmcnt(0) lgkmcnt(0)
  s_mov_b32 s14, 0
L_mlw:
  s_sleep 3
  ds_read_b128 v[48:51], v70 offset:1024
  ds_read_b128 v[52:55], v70 offset:1040
  s_add_u32 s14, s14, 1
  s_waitcnt lgkmcnt(0)
  v_or3_b32 v9, v49, v51, v53
  v_or_b32 v9, v9, v55
  s_nop 0
  v_readfirstlane_b32 s10, v9
  s_cmp_ge_u32 s14, 1048576
  s_cbranch_scc1 L_mlw2
  s_cmp_lt_i32 s10, 0
  s_cbranch_scc1 L_mlw
L_mlw2:
  v_max3_f32 v80, v48, v50, v52
  v_max_f32 v80, v80, v54
  v_sub_f32 v48, v48, v80
  v_sub_f32 v50, v50, v80
  v_sub_f32 v52, v52, v80
  v_sub_f32 v54, v54, v80
  v_mul_f32 v48, s12, v48
  v_mul_f32 v50, s12, v50
  v_mul_f32 v52, s12, v52
  v_mul_f32 v54, s12, v54
  v_exp_f32 v48, v48
  v_exp_f32 v50, v50
  v_exp_f32 v52, v52
  v_exp_f32 v54, v54
  s_nop 0
  v_mul_f32 v82, v48, v49
  v_fmac_f32 v82, v50, v51
  v_fmac_f32 v82, v52, v53
  v_fmac_f32 v82, v54, v55
  s_cmp_lg_u32 s7, 2
  s_cbranch_scc1 L_noml0
  s_memrealtime s[76:77]
  s_waitcnt lgkmcnt(0)
  s_and_b32 s76, s76, 0xffff
  v_or_b32 v80, s76, v80
  s_mov_b64 exec, 1
  buffer_store_dwordx4 v[80:83], v65, s[52:55], s9 offen sc1
  s_mov_b64 exec, -1
L_noml0:
  s_setprio 2
  s_barrier
  ds_read_b32 v56, v66 offset:1280
  ds_read_b32 v57, v66 offset:1792
  ds_read_b32 v58, v66 offset:2304
  ds_read_b32 v59, v66 offset:2816
  s_waitcnt lgkmcnt(0)
  v_mul_f32 v10, v48, v56
  v_fmac_f32 v10, v50, v57
  v_fmac_f32 v10, v52, v58
  v_fmac_f32 v10, v54, v59
  v_cvt_pk_bf16_f32 v64, v10, v10
  s_cmp_lg_u32 s7, 99
  s_cbranch_scc1 L_noml
  s_memrealtime s[76:77]
  s_waitcnt lgkmcnt(0)
  s_and_b32 s76, s76, 0xffff
  v_or_b32 v80, s76, v80
  s_mov_b64 exec, 1
  buffer_store_dwordx4 v[80:83], v65, s[52:55], s9 offen sc1
  s_mov_b64 exec, -1
L_noml:
  v_and_b32_dpp v16, v64, v4 row_newbcast:0 row_mask:0xf bank_mask:0xf
  v_and_b32_dpp v17, v64, v5 row_newbcast:0 row_mask:0xf bank_mask:0xf
  v_and_b32_dpp v18, v64, v6 row_newbcast:0 row_mask:0xf bank_mask:0xf
  v_and_b32_dpp v19, v64, v7 row_newbcast:0 row_mask:0xf bank_mask:0xf
  s_nop 1
  v_mfma_f32_16x16x32_bf16 v[24:27], v[16:19], v[96:99], 0
  v_and_b32_dpp v20, v64, v4 row_newbcast:1 row_mask:0xf bank_mask:0xf
  v_and_b32_dpp v21, v64, v5 row_newbcast:1 row_mask:0xf bank_mask:0xf
  v_mfma_f32_16x16x32_bf16 v[28:31], v[16:19], v[100:103], 0
  v_and_b32_dpp v22, v64, v6 row_newbcast:1 row_mask:0xf bank_mask:0xf
  v_and_b32_dpp v23, v64, v7 row_newbcast:1 row_mask:0xf bank_mask:0xf
  v_mfma_f32_16x16x32_bf16 v[32:35], v[16:19], v[104:107], 0
  v_mfma_f32_16x16x32_bf16 v[36:39], v[16:19], v[108:111], 0
  v_mfma_f32_16x16x32_bf16 v[84:87], v[16:19], v[112:115], 0
  v_mfma_f32_16x16x32_bf16 v[24:27], v[20:23], v[116:119], v[24:27]
  v_and_b32_dpp v16, v64, v4 row_newbcast:2 row_mask:0xf bank_mask:0xf
  v_and_b32_dpp v17, v64, v5 row_newbcast:2 row_mask:0xf bank_mask:0xf
  v_mfma_f32_16x16x32_bf16 v[28:31], v[20:23], v[120:123], v[28:31]
  v_and_b32_dpp v18, v64, v6 row_newbcast:2 row_mask:0xf bank_mask:0xf
  v_and_b32_dpp v19, v64, v7 row_newbcast:2 row_mask:0xf bank_mask:0xf
  v_mfma_f32_16x16x32_bf16 v[32:35], v[20:23], v[124:127], v[32:35]
  v_mfma_f32_16x16x32_bf16 v[36:39], v[20:23], v[128:131], v[36:39]
  v_mfma_f32_16x16x32_bf16 v[84:87], v[20:23], v[132:135], v[84:87]
  v_mfma_f32_16x16x32_bf16 v[24:27], v[16:19], v[136:139], v[24:27]
  v_and_b32_dpp v20, v64, v4 row_newbcast:3 row_mask:0xf bank_mask:0xf
  v_and_b32_dpp v21, v64, v5 row_newbcast:3 row_mask:0xf bank_mask:0xf
  v_mfma_f32_16x16x32_bf16 v[28:31], v[16:19], v[140:143], v[28:31]
  v_and_b32_dpp v22, v64, v6 row_newbcast:3 row_mask:0xf bank_mask:0xf
  v_and_b32_dpp v23, v64, v7 row_newbcast:3 row_mask:0xf bank_mask:0xf
  v_mfma_f32_16x16x32_bf16 v[32:35], v[16:19], v[144:147], v[32:35]
  v_mfma_f32_16x16x32_bf16 v[36:39], v[16:19], v[148:151], v[36:39]
  v_mfma_f32_16x16x32_bf16 v[84:87], v[16:19], v[152:155], v[84:87]
  v_mfma_f32_16x16x32_bf16 v[24:27], v[20:23], v[156:159], v[24:27]
  v_and_b32_dpp v16, v64, v4 row_newbcast:4 row_mask:0xf bank_mask:0xf
  v_and_b32_dpp v17, v64, v5 row_newbcast:4 row_mask:0xf bank_mask:0xf
  v_mfma_f32_16x16x32_bf16 v[28:31], v[20:23], v[160:163], v[28:31]
  v_and_b32_dpp v18, v64, v6 row_newbcast:4 row_mask:0xf bank_mask:0xf
  v_and_b32_dpp v19, v64, v7 row_newbcast:4 row_mask:0xf bank_mask:0xf
  v_mfma_f32_16x16x32_bf16 v[32:35], v[20:23], v[164:167], v[32:35]
  v_mfma_f32_16x16x32_bf16 v[36:39], v[20:23], v[168:171], v[36:39]
  v_mfma_f32_16x16x32_bf16 v[84:87], v[20:23], v[172:175], v[84:87]
  v_mfma_f32_16x16x32_bf16 v[24:27], v[16:19], v[176:179], v[24:27]
  v_and_b32_dpp v20, v64, v4 row_newbcast:5 row_mask:0xf bank_mask:0xf
  v_and_b32_dpp v21, v64, v5 row_newbcast:5 row_mask:0xf bank_mask:0xf
  v_mfma_f32_16x16x32_bf16 v[28:31], v[16:19], v[180:183], v[28:31]
  v_and_b32_dpp v22, v64, v6 row_newbcast:5 row_mask:0xf bank_mask:0xf
  v_and_b32_dpp v23, v64, v7 row_newbcast:5 row_mask:0xf bank_mask:0xf
  v_mfma_f32_16x16x32_bf16 v[32:35], v[16:19], v[184:187], v[32:35]
  v_mfma_f32_16x16x32_bf16 v[36:39], v[16:19], v[188:191], v[36:39]
  v_mfma_f32_16x16x32_bf16 v[84:87], v[16:19], v[192:195], v[84:87]
  v_mfma_f32_16x16x32_bf16 v[24:27], v[20:23], v[196:199], v[24:27]
  v_and_b32_dpp v16, v64, v4 row_newbcast:6 row_mask:0xf bank_mask:0xf
  v_and_b32_dpp v17, v64, v5 row_newbcast:6 row_mask:0xf bank_mask:0xf
  v_mfma_f32_16x16x32_bf16 v[28:31], v[20:23], v[200:203], v[28:31]
  v_and_b32_dpp v18, v64, v6 row_newbcast:6 row_mask:0xf bank_mask:0xf
  v_and_b32_dpp v19, v64, v7 row_newbcast:6 row_mask:0xf bank_mask:0xf
  v_mfma_f32_16x16x32_bf16 v[32:35], v[20:23], v[204:207], v[32:35]
  v_mfma_f32_16x16x32_bf16 v[36:39], v[20:23], v[208:211], v[36:39]
  v_mfma_f32_16x16x32_bf16 v[84:87], v[20:23], v[212:215], v[84:87]
  v_mfma_f32_16x16x32_bf16 v[24:27], v[16:19], v[216:219], v[24:27]
  v_and_b32_dpp v20, v64, v4 row_newbcast:7 row_mask:0xf bank_mask:0xf
  v_and_b32_dpp v21, v64, v5 row_newbcast:7 row_mask:0xf bank_mask:0xf
  v_mfma_f32_16x16x32_bf16 v[28:31], v[16:19], v[220:223], v[28:31]
  v_and_b32_dpp v22, v64, v6 row_newbcast:7 row_mask:0xf bank_mask:0xf
  v_and_b32_dpp v23, v64, v7 row_newbcast:7 row_mask:0xf bank_mask:0xf
  v_mfma_f32_16x16x32_bf16 v[32:35], v[16:19], v[224:227], v[32:35]
  v_mfma_f32_16x16x32_bf16 v[36:39], v[16:19], v[228:231], v[36:39]
  v_mfma_f32_16x16x32_bf16 v[84:87], v[16:19], v[232:235], v[84:87]
  v_mfma_f32_16x16x32_bf16 v[24:27], v[20:23], v[236:239], v[24:27]
  v_mfma_f32_16x16x32_bf16 v[28:31], v[20:23], v[240:243], v[28:31]
  v_mfma_f32_16x16x32_bf16 v[32:35], v[20:23], v[244:247], v[32:35]
  v_mfma_f32_16x16x32_bf16 v[36:39], v[20:23], v[248:251], v[36:39]
  v_mfma_f32_16x16x32_bf16 v[84:87], v[20:23], v[252:255], v[84:87]
  s_nop 3
  s_mov_b32 exec_hi, 0
  ds_write_b128 v67, v[24:27] offset:8192
  ds_write_b128 v67, v[28:31] offset:8704
  ds_write_b128 v67, v[32:35] offset:9216
  ds_write_b128 v67, v[36:39] offset:9728
  s_mov_b32 exec_lo, 0x00ff00ff
  ds_write_b128 v67, v[84:87] offset:10240
  s_mov_b64 exec, -1
  s_waitcnt lgkmcnt(0)
  s_barrier
  ds_read_b64 v[48:49], v68 offset:8192
  ds_read_b64 v[50:51], v68 offset:10496
  ds_read_b64 v[52:53], v68 offset:12800
  ds_read_b64 v[54:55], v68 offset:15104
  ds_read_b64 v[56:57], v68 offset:3328
  s_waitcnt lgkmcnt(1)
  v_add_f32 v48, v48, v50
  v_add_f32 v52, v52, v54
  v_add_f32 v49, v49, v51
  v_add_f32 v53, v53, v55
  v_add_f32 v48, v48, v52
  v_add_f32 v49, v49, v53
  s_waitcnt lgkmcnt(0)
  v_cndmask_b32 v40, v56, v48, s[62:63]
  v_cndmask_b32 v42, v57, v49, s[62:63]
  buffer_store_dwordx4 v[40:43], v69, s[52:55], s60 offen offset:0 sc1
  s_cmp_lg_u32 s7, 3
  s_cbranch_scc1 L_nox
  s_nop 1
  ds_read_b64 v[48:49], v68 offset:8448
  ds_read_b64 v[50:51], v68 offset:10752
  ds_read_b64 v[52:53], v68 offset:13056
  ds_read_b64 v[54:55], v68 offset:15360
  ds_read_b64 v[56:57], v68 offset:3584
  s_waitcnt lgkmcnt(1)
  v_add_f32 v48, v48, v50
  v_add_f32 v52, v52, v54
  v_add_f32 v49, v49, v51
  v_add_f32 v53, v53, v55
  v_add_f32 v48, v48, v52
  v_add_f32 v49, v49, v53
  s_waitcnt lgkmcnt(0)
  v_cndmask_b32 v40, v56, v48, s[62:63]
  v_cndmask_b32 v42, v57, v49, s[62:63]
  buffer_store_dwordx4 v[40:43], v69, s[52:55], s60 offen offset:1024 sc1
L_nox:
  s_endpgm
L_stream2:
  s_mov_b32 s11, 5898240
  s_load_dword s15, s[38:39], s11
  v_lshlrev_b32 v8, 4, v1
  v_add_u32 v47, s10, v8
  s_mov_b32 s40, s16
  s_mov_b32 s41, s17
  s_mov_b32 s42, 1152
  s_mov_b32 s43, 0x20000
  s_mov_b32 s52, s38
  s_mov_b32 s53, s39
  s_mov_b32 s54, 12582912
  s_mov_b32 s55, 0x20000
  s_mov_b32 s48, s32
  s_mov_b32 s49, s33
  s_mov_b32 s50, 5308416
  s_mov_b32 s51, 0x20000
  v_and_b32 v8, 1, v3
  v_lshlrev_b32 v8, 4, v8
  s_mov_b32 s10, 0xffff
  v_lshlrev_b32 v8, v8, s10
  v_lshrrev_b32 v11, 1, v3
  v_cmp_eq_u32 vcc, 0, v11
  s_nop 1
  v_cndmask_b32 v4, 0, v8, vcc
  v_cmp_eq_u32 vcc, 1, v11
  s_nop 1
  v_cndmask_b32 v5, 0, v8, vcc
  v_cmp_eq_u32 vcc, 2, v11
  s_nop 1
  v_cndmask_b32 v6, 0, v8, vcc
  v_cmp_eq_u32 vcc, 3, v11
  s_nop 1
  v_cndmask_b32 v7, 0, v8, vcc
  s_mul_i32 s12, s3, 288
  v_mul_u32_u24 v8, 1152, v2
  v_lshl_add_u32 v8, v3, 4, v8
  v_add_u32 v32, s12, v8
  v_add_u32 v8, 256, v32
  v_mov_b32 v9, 1073741824
  v_cmp_gt_u32 vcc, 2, v3
  s_nop 1
  v_cndmask_b32 v33, v9, v8, vcc
  v_cmp_gt_u32 vcc, 32, v1
  s_and_b32 s0, s2, 7
  s_mul_i32 s0, s0, 18
  s_lshr_b32 s1, s2, 3
  s_add_u32 s0, s0, s1
  s_lshl_b32 s10, s0, 3
  v_mov_b32 v10, s10
  v_cndmask_b32 v34, v9, v32, vcc
  v_cndmask_b32 v35, v9, v33, vcc
  v_and_b32 v8, 3, v3
  v_lshrrev_b32 v9, 2, v3
  v_cmp_eq_u32 s[60:61], 0, v8
  v_cmp_eq_u32 s[68:69], 0, v9
  v_cmp_eq_u32 s[62:63], 1, v8
  v_cmp_eq_u32 s[70:71], 1, v9
  v_cmp_eq_u32 s[64:65], 2, v8
  v_cmp_eq_u32 s[72:73], 2, v9
  v_cmp_eq_u32 s[66:67], 3, v8
  v_cmp_eq_u32 s[74:75], 3, v9
  v_lshlrev_b32 v9, 2, v2
  v_add_u32 v8, v8, v9
  v_lshlrev_b32 v8, 5, v8
  buffer_load_dwordx2 v[80:81], v10, s[40:43], 0 offen
  s_waitcnt vmcnt(4)
  buffer_load_dwordx4 v[152:155], v46, s[44:47], s8 offen nt
  s_add_u32 s8, s8, 4096
  s_waitcnt vmcnt(4)
  buffer_load_dwordx4 v[156:159], v46, s[44:47], s8 offen nt
  s_add_u32 s8, s8, 4096
  s_waitcnt vmcnt(4)
  buffer_load_dwordx4 v[160:163], v46, s[44:47], s8 offen nt
  s_add_u32 s8, s8, 4096
  s_waitcnt vmcnt(4)
  buffer_load_dwordx4 v[164:167], v46, s[44:47], s8 offen nt
  s_add_u32 s8, s8, 4096
  s_waitcnt vmcnt(4)
  buffer_load_dwordx4 v[168:171], v46, s[44:47], s8 offen nt
  s_add_u32 s8, s8, 4096
  s_waitcnt vmcnt(4)
  buffer_load_dwordx4 v[172:175], v46, s[44:47], s8 offen nt
  s_add_u32 s8, s8, 4096
  s_waitcnt vmcnt(4)
  buffer_load_dwordx4 v[176:179], v46, s[44:47], s8 offen nt
  s_add_u32 s8, s8, 4096
  s_waitcnt vmcnt(4)
  buffer_load_dwordx4 v[180:183], v46, s[44:47], s8 offen nt
  s_add_u32 s8, s8, 4096
  s_waitcnt vmcnt(4)
  buffer_load_dwordx4 v[184:187], v46, s[44:47], s8 offen nt
  s_add_u32 s8, s8, 4096
  s_waitcnt vmcnt(4)
  buffer_load_dwordx4 v[188:191], v46, s[44:47], s8 offen nt
  s_add_u32 s8, s8, 4096
  s_waitcnt vmcnt(4)
  buffer_load_dwordx4 v[192:195], v46, s[44:47], s8 offen nt
  s_add_u32 s8, s8, 4096
  s_waitcnt vmcnt(4)
  buffer_load_dwordx4 v[196:199], v46, s[44:47], s8 offen nt
  s_add_u32 s8, s8, 4096
  s_waitcnt vmcnt(4)
  buffer_load_dwordx4 v[200:203], v46, s[44:47], s8 offen nt
  s_add_u32 s8, s8, 4096
  s_waitcnt vmcnt(4)
  buffer_load_dwordx4 v[204:207], v46, s[44:47], s8 offen nt
  s_add_u32 s8, s8, 4096
  s_waitcnt vmcnt(4)
  buffer_load_dwordx4 v[208:211], v46, s[44:47], s8 offen nt
  s_add_u32 s8, s8, 4096
  s_waitcnt vmcnt(4)
  buffer_load_dwordx4 v[212:215], v46, s[44:47], s8 offen nt
  s_add_u32 s8, s8, 4096
  s_waitcnt vmcnt(4)
  buffer_load_dwordx4 v[216:219], v46, s[44:47], s8 offen nt
  s_add_u32 s8, s8, 4096
  s_waitcnt vmcnt(4)
  buffer_load_dwordx4 v[220:223], v46, s[44:47], s8 offen nt
  s_add_u32 s8, s8, 4096
  s_waitcnt vmcnt(4)
  buffer_load_dwordx4 v[224:227], v46, s[44:47], s8 offen nt
  s_add_u32 s8, s8, 4096
  s_waitcnt vmcnt(4)
  buffer_load_dwordx4 v[228:231], v46, s[44:47], s8 offen nt
  s_add_u32 s8, s8, 4096
  s_waitcnt vmcnt(4)
  buffer_load_dwordx4 v[232:235], v46, s[44:47], s8 offen nt
  s_add_u32 s8, s8, 4096
  s_waitcnt vmcnt(4)
  buffer_load_dwordx4 v[236:239], v46, s[44:47], s8 offen nt
  s_add_u32 s8, s8, 4096
  s_waitcnt vmcnt(4)
  buffer_load_dwordx4 v[240:243], v46, s[44:47], s8 offen nt
  s_add_u32 s8, s8, 4096
  s_waitcnt vmcnt(4)
  buffer_load_dwordx4 v[244:247], v46, s[44:47], s8 offen nt
  s_add_u32 s8, s8, 4096
  s_waitcnt vmcnt(4)
  buffer_load_dwordx4 v[248:251], v46, s[44:47], s8 offen nt
  s_add_u32 s8, s8, 4096
  s_waitcnt vmcnt(4)
  buffer_load_dwordx4 v[252:255], v46, s[44:47], s8 offen nt
  s_add_u32 s8, s8, 4096
  s_waitcnt lgkmcnt(0)
  s_add_u32 s15, s15, 2654435769
  s_barrier
  ds_read_b128 v[84:87], v8 offset:0
  ds_read_b128 v[88:91], v8 offset:16
  s_waitcnt lgkmcnt(0)
  v_cvt_pk_bf16_f32 v92, v84, v85
  v_cvt_pk_bf16_f32 v93, v86, v87
  v_cvt_pk_bf16_f32 v94, v88, v89
  v_cvt_pk_bf16_f32 v95, v90, v91
  v_cndmask_b32 v48, 0, v92, s[68:69]
  v_cndmask_b32 v49, 0, v93, s[68:69]
  v_cndmask_b32 v50, 0, v94, s[68:69]
  v_cndmask_b32 v51, 0, v95, s[68:69]
  v_cndmask_b32 v52, 0, v92, s[70:71]
  v_cndmask_b32 v53, 0, v93, s[70:71]
  v_cndmask_b32 v54, 0, v94, s[70:71]
  v_cndmask_b32 v55, 0, v95, s[70:71]
  v_cndmask_b32 v56, 0, v92, s[72:73]
  v_cndmask_b32 v57, 0, v93, s[72:73]
  v_cndmask_b32 v58, 0, v94, s[72:73]
  v_cndmask_b32 v59, 0, v95, s[72:73]
  v_cndmask_b32 v60, 0, v92, s[74:75]
  v_cndmask_b32 v61, 0, v93, s[74:75]
  v_cndmask_b32 v62, 0, v94, s[74:75]
  v_cndmask_b32 v63, 0, v95, s[74:75]
  s_mov_b32 s78, 0
  v_mov_b32 v121, 0
  v_mov_b32 v122, 512
  s_mov_b64 vcc, 0
  s_mov_b32 s75, 0
  s_mov_b32 s12, 1035273459
  s_mov_b32 s9, 0
L_kloop:
  s_cmp_eq_u32 s9, 3
  s_cbranch_scc0 L_kbody
  s_mov_b32 s44, s20
  s_mov_b32 s45, s21
  s_mov_b32 s8, 0
  v_mov_b32 v46, v47
L_kbody:
  v_mfma_f32_16x16x32_bf16 v[64:67], v[128:131], v[48:51], 0
  s_cmp_gt_i32 s75, 50
  s_cbranch_scc1 L_pc1b
  s_cbranch_vccnz L_pc1
  s_cmp_gt_i32 s75, -60
  s_cbranch_scc1 L_pc1a
  s_waitcnt vmcnt(3)
L_pc1a:
  s_waitcnt vmcnt(4)
L_pc1:
  s_waitcnt vmcnt(5)
L_pc1b:
  s_waitcnt vmcnt(7)
  buffer_load_dwordx4 v[128:131], v46, s[44:47], s8 offen nt
  s_add_u32 s8, s8, 4096
  s_memrealtime s[76:77]
  ds_read_b32 v123, v122 offset:8
  v_mfma_f32_16x16x32_bf16 v[64:67], v[132:135], v[52:55], v[64:67]
  s_cmp_gt_i32 s75, 50
  s_cbranch_scc1 L_pc2b
  s_cbranch_vccnz L_pc2
  s_cmp_gt_i32 s75, -60
  s_cbranch_scc1 L_pc2a
  s_waitcnt vmcnt(3)
L_pc2a:
  s_waitcnt vmcnt(4)
L_pc2:
  s_waitcnt vmcnt(5)
L_pc2b:
  s_waitcnt vmcnt(7)
  buffer_load_dwordx4 v[132:135], v46, s[44:47], s8 offen nt
  s_add_u32 s8, s8, 4096
  v_mfma_f32_16x16x32_bf16 v[64:67], v[136:139], v[56:59], v[64:67]
  s_cmp_gt_i32 s75, 50
  s_cbranch_scc1 L_pc3b
  s_cbranch_vccnz L_pc3
  s_cmp_gt_i32 s75, -60
  s_cbranch_scc1 L_pc3a
  s_waitcnt vmcnt(3)
L_pc3a:
  s_waitcnt vmcnt(4)
L_pc3:
  s_waitcnt vmcnt(5)
L_pc3b:
  s_waitcnt vmcnt(7)
  buffer_load_dwordx4 v[136:139], v46, s[44:47], s8 offen nt
  s_add_u32 s8, s8, 4096
  s_waitcnt lgkmcnt(0)
  v_readfirstlane_b32 s79, v123
  s_cmp_lg_u32 s3, 0
  s_cbranch_scc1 L_ck4
  v_mov_b32 v120, s76
  v_add_u32 v121, 1, v121
  v_lshl_add_u32 v119, v121, 2, v122
  ds_write_b32 v119, v120 offset:28
  ds_write_b64 v122, v[120:121] offset:16
L_ck4:
  s_sub_u32 s76, s76, s79
  s_sub_u32 s76, s76, s78
  s_abs_i32 s77, s76
  s_cmp_gt_u32 s77, 100000
  s_cselect_b32 s75, 0, s76
  s_cmp_gt_i32 s75, 0
  s_cselect_b64 vcc, -1, 0
  s_add_u32 s78, s78, 118
  v_mfma_f32_16x16x32_bf16 v[64:67], v[140:143], v[60:63], v[64:67]
  s_cmp_gt_i32 s75, 50
  s_cbranch_scc1 L_pc5b
  s_cbranch_vccnz L_pc5
  s_cmp_gt_i32 s75, -60
  s_cbranch_scc1 L_pc5a
  s_waitcnt vmcnt(3)
L_pc5a:
  s_waitcnt vmcnt(4)
L_pc5:
  s_waitcnt vmcnt(5)
L_pc5b:
  s_waitcnt vmcnt(7)
  buffer_load_dwordx4 v[140:143], v46, s[44:47], s8 offen nt
  s_add_u32 s8, s8, 4096
  s_nop 5
  v_mov_b32_dpp v8, v64 quad_perm:[0,0,0,0] row_mask:0xf bank_mask:0xf
  v_add_f32_dpp v8, v65, v8 quad_perm:[1,1,1,1] row_mask:0xf bank_mask:0xf
  v_add_f32_dpp v8, v66, v8 quad_perm:[2,2,2,2] row_mask:0xf bank_mask:0xf
  v_add_f32_dpp v8, v67, v8 quad_perm:[3,3,3,3] row_mask:0xf bank_mask:0xf
  v_mov_b32 v76, v8
  v_mfma_f32_16x16x32_bf16 v[64:67], v[144:147], v[48:51], 0
  s_cmp_gt_i32 s75, 50
  s_cbranch_scc1 L_pc6b
  s_cbranch_vccnz L_pc6
  s_cmp_gt_i32 s75, -60
  s_cbranch_scc1 L_pc6a
  s_waitcnt vmcnt(3)
L_pc6a:
  s_waitcnt vmcnt(4)
L_pc6:
  s_waitcnt vmcnt(5)
L_pc6b:
  s_waitcnt vmcnt(7)
  buffer_load_dwordx4 v[144:147], v46, s[44:47], s8 offen nt
  s_add_u32 s8, s8, 4096
  v_mfma_f32_16x16x32_bf16 v[64:67], v[148:151], v[52:55], v[64:67]
  s_cmp_gt_i32 s75, 50
  s_cbranch_scc1 L_pc7b
  s_cbranch_vccnz L_pc7
  s_cmp_gt_i32 s75, -60
  s_cbranch_scc1 L_pc7a
  s_waitcnt vmcnt(3)
L_pc7a:
  s_waitcnt vmcnt(4)
L_pc7:
  s_waitcnt vmcnt(5)
L_pc7b:
  s_waitcnt vmcnt(7)
  buffer_load_dwordx4 v[148:151], v46, s[44:47], s8 offen nt
  s_add_u32 s8, s8, 4096
  v_mfma_f32_16x16x32_bf16 v[64:67], v[152:155], v[56:59], v[64:67]
  s_cmp_gt_i32 s75, 50
  s_cbranch_scc1 L_pc8b
  s_cbranch_vccnz L_pc8
  s_cmp_gt_i32 s75, -60
  s_cbranch_scc1 L_pc8a
  s_waitcnt vmcnt(3)
L_pc8a:
  s_waitcnt vmcnt(4)
L_pc8:
  s_waitcnt vmcnt(5)
L_pc8b:
  s_waitcnt vmcnt(7)
  buffer_load_dwordx4 v[152:155], v46, s[44:47], s8 offen nt
  s_add_u32 s8, s8, 4096
  v_mfma_f32_16x16x32_bf16 v[64:67], v[156:159], v[60:63], v[64:67]
  s_cmp_gt_i32 s75, 50
  s_cbranch_scc1 L_pc9b
  s_cbranch_vccnz L_pc9
  s_cmp_gt_i32 s75, -60
  s_cbranch_scc1 L_pc9a
  s_waitcnt vmcnt(3)
L_pc9a:
  s_waitcnt vmcnt(4)
L_pc9:
  s_waitcnt vmcnt(5)
L_pc9b:
  s_waitcnt vmcnt(7)
  buffer_load_dwordx4 v[156:159], v46, s[44:47], s8 offen nt
  s_add_u32 s8, s8, 4096
  s_nop 5
  v_mov_b32_dpp v8, v64 quad_perm:[0,0,0,0] row_mask:0xf bank_mask:0xf
  v_add_f32_dpp v8, v65, v8 quad_perm:[1,1,1,1] row_mask:0xf bank_mask:0xf
  v_add_f32_dpp v8, v66, v8 quad_perm:[2,2,2,2] row_mask:0xf bank_mask:0xf
  v_add_f32_dpp v8, v67, v8 quad_perm:[3,3,3,3] row_mask:0xf bank_mask:0xf
  v_cndmask_b32 v76, v76, v8, s[62:63]
  v_mfma_f32_16x16x32_bf16 v[64:67], v[160:163], v[48:51], 0
  s_cmp_gt_i32 s75, 50
  s_cbranch_scc1 L_pc10b
  s_cbranch_vccnz L_pc10
  s_cmp_gt_i32 s75, -60
  s_cbranch_scc1 L_pc10a
  s_waitcnt vmcnt(3)
L_pc10a:
  s_waitcnt vmcnt(4)
L_pc10:
  s_waitcnt vmcnt(5)
L_pc10b:
  s_waitcnt vmcnt(7)
  buffer_load_dwordx4 v[160:163], v46, s[44:47], s8 offen nt
  s_add_u32 s8, s8, 4096
  s_memrealtime s[76:77]
  ds_read_b32 v123, v122 offset:8
  v_mfma_f32_16x16x32_bf16 v[64:67], v[164:167], v[52:55], v[64:67]
  s_cmp_gt_i32 s75, 50
  s_cbranch_scc1 L_pc11b
  s_cbranch_vccnz L_pc11
  s_cmp_gt_i32 s75, -60
  s_cbranch_scc1 L_pc11a
  s_waitcnt vmcnt(3)
L_pc11a:
  s_waitcnt vmcnt(4)
L_pc11:
  s_waitcnt vmcnt(5)
L_pc11b:
  s_waitcnt vmcnt(7)
  buffer_load_dwordx4 v[164:167], v46, s[44:47], s8 offen nt
  s_add_u32 s8, s8, 4096
  v_mfma_f32_16x16x32_bf16 v[64:67], v[168:171], v[56:59], v[64:67]
  s_cmp_gt_i32 s75, 50
  s_cbranch_scc1 L_pc12b
  s_cbranch_vccnz L_pc12
  s_cmp_gt_i32 s75, -60
  s_cbranch_scc1 L_pc12a
  s_waitcnt vmcnt(3)
L_pc12a:
  s_waitcnt vmcnt(4)
L_pc12:
  s_waitcnt vmcnt(5)
L_pc12b:
  s_waitcnt vmcnt(7)
  buffer_load_dwordx4 v[168:171], v46, s[44:47], s8 offen nt
  s_add_u32 s8, s8, 4096
  s_waitcnt lgkmcnt(0)
  v_readfirstlane_b32 s79, v123
  s_sub_u32 s76, s76, s79
  s_sub_u32 s76, s76, s78
  s_abs_i32 s77, s76
  s_cmp_gt_u32 s77, 100000
  s_cselect_b32 s75, 0, s76
  s_cmp_gt_i32 s75, 0
  s_cselect_b64 vcc, -1, 0
  s_add_u32 s78, s78, 118
  v_mfma_f32_16x16x32_bf16 v[64:67], v[172:175], v[60:63], v[64:67]
  s_cmp_gt_i32 s75, 50
  s_cbranch_scc1 L_pc13b
  s_cbranch_vccnz L_pc13
  s_cmp_gt_i32 s75, -60
  s_cbranch_scc1 L_pc13a
  s_waitcnt vmcnt(3)
L_pc13a:
  s_waitcnt vmcnt(4)
L_pc13:
  s_waitcnt vmcnt(5)
L_pc13b:
  s_waitcnt vmcnt(7)
  buffer_load_dwordx4 v[172:175], v46, s[44:47], s8 offen nt
  s_add_u32 s8, s8, 4096
  s_nop 5
  v_mov_b32_dpp v8, v64 quad_perm:[0,0,0,0] row_mask:0xf bank_mask:0xf
  v_add_f32_dpp v8, v65, v8 quad_perm:[1,1,1,1] row_mask:0xf bank_mask:0xf
  v_add_f32_dpp v8, v66, v8 quad_perm:[2,2,2,2] row_mask:0xf bank_mask:0xf
  v_add_f32_dpp v8, v67, v8 quad_perm:[3,3,3,3] row_mask:0xf bank_mask:0xf
  v_cndmask_b32 v76, v76, v8, s[64:65]
  v_mfma_f32_16x16x32_bf16 v[64:67], v[176:179], v[48:51], 0
  s_cmp_gt_i32 s75, 50
  s_cbranch_scc1 L_pc14b
  s_cbranch_vccnz L_pc14
  s_cmp_gt_i32 s75, -60
  s_cbranch_scc1 L_pc14a
  s_waitcnt vmcnt(3)
L_pc14a:
  s_waitcnt vmcnt(4)
L_pc14:
  s_waitcnt vmcnt(5)
L_pc14b:
  s_waitcnt vmcnt(7)
  buffer_load_dwordx4 v[176:179], v46, s[44:47], s8 offen nt
  s_add_u32 s8, s8, 4096
  v_mfma_f32_16x16x32_bf16 v[64:67], v[180:183], v[52:55], v[64:67]
  s_cmp_gt_i32 s75, 50
  s_cbranch_scc1 L_pc15b
  s_cbranch_vccnz L_pc15
  s_cmp_gt_i32 s75, -60
  s_cbranch_scc1 L_pc15a
  s_waitcnt vmcnt(3)
L_pc15a:
  s_waitcnt vmcnt(4)
L_pc15:
  s_waitcnt vmcnt(5)
L_pc15b:
  s_waitcnt vmcnt(7)
  buffer_load_dwordx4 v[180:183], v46, s[44:47], s8 offen nt
  s_add_u32 s8, s8, 4096
  v_mfma_f32_16x16x32_bf16 v[64:67], v[184:187], v[56:59], v[64:67]
  s_cmp_gt_i32 s75, 50
  s_cbranch_scc1 L_pc16b
  s_cbranch_vccnz L_pc16
  s_cmp_gt_i32 s75, -60
  s_cbranch_scc1 L_pc16a
  s_waitcnt vmcnt(3)
L_pc16a:
  s_waitcnt vmcnt(4)
L_pc16:
  s_waitcnt vmcnt(5)
L_pc16b:
  s_waitcnt vmcnt(7)
  buffer_load_dwordx4 v[184:187], v46, s[44:47], s8 offen nt
  s_add_u32 s8, s8, 4096
  v_mfma_f32_16x16x32_bf16 v[64:67], v[188:191], v[60:63], v[64:67]
  s_cmp_gt_i32 s75, 50
  s_cbranch_scc1 L_pc17b
  s_cbranch_vccnz L_pc17
  s_cmp_gt_i32 s75, -60
  s_cbranch_scc1 L_pc17a
  s_waitcnt vmcnt(3)
L_pc17a:
  s_waitcnt vmcnt(4)
L_pc17:
  s_waitcnt vmcnt(5)
L_pc17b:
  s_waitcnt vmcnt(7)
  buffer_load_dwordx4 v[188:191], v46, s[44:47], s8 offen nt
  s_add_u32 s8, s8, 4096
  s_nop 5
  v_mov_b32_dpp v8, v64 quad_perm:[0,0,0,0] row_mask:0xf bank_mask:0xf
  v_add_f32_dpp v8, v65, v8 quad_perm:[1,1,1,1] row_mask:0xf bank_mask:0xf
  v_add_f32_dpp v8, v66, v8 quad_perm:[2,2,2,2] row_mask:0xf bank_mask:0xf
  v_add_f32_dpp v8, v67, v8 quad_perm:[3,3,3,3] row_mask:0xf bank_mask:0xf
  v_cndmask_b32 v76, v76, v8, s[66:67]
  v_cvt_pk_bf16_f32 v76, v76, v76
  v_lshlrev_b32 v76, 16, v76
  v_mul_f32 v76, s12, v76
  v_cvt_pk_bf16_f32 v76, v76, v76
  v_lshlrev_b32 v76, 16, v76
  v_mov_b32 v68, v69
  v_mov_b32 v69, v70
  v_mov_b32 v70, v71
  v_mov_b32 v71, v72
  v_mov_b32 v72, v73
  v_mov_b32 v73, v74
  v_mov_b32 v74, v75
  v_mov_b32 v75, v76
  v_mfma_f32_16x16x32_bf16 v[64:67], v[192:195], v[48:51], 0
  s_cmp_gt_i32 s75, 50
  s_cbranch_scc1 L_pc18b
  s_cbranch_vccnz L_pc18
  s_cmp_gt_i32 s75, -60
  s_cbranch_scc1 L_pc18a
  s_waitcnt vmcnt(3)
L_pc18a:
  s_waitcnt vmcnt(4)
L_pc18:
  s_waitcnt vmcnt(5)
L_pc18b:
  s_waitcnt vmcnt(7)
  buffer_load_dwordx4 v[192:195], v46, s[44:47], s8 offen nt
  s_add_u32 s8, s8, 4096
  s_memrealtime s[76:77]
  ds_read_b32 v123, v122 offset:8
  v_mfma_f32_16x16x32_bf16 v[64:67], v[196:199], v[52:55], v[64:67]
  s_cmp_gt_i32 s75, 50
  s_cbranch_scc1 L_pc19b
  s_cbranch_vccnz L_pc19
  s_cmp_gt_i32 s75, -60
  s_cbranch_scc1 L_pc19a
  s_waitcnt vmcnt(3)
L_pc19a:
  s_waitcnt vmcnt(4)
L_pc19:
  s_waitcnt vmcnt(5)
L_pc19b:
  s_waitcnt vmcnt(7)
  buffer_load_dwordx4 v[196:199], v46, s[44:47], s8 offen nt
  s_add_u32 s8, s8, 4096
  v_mfma_f32_16x16x32_bf16 v[64:67], v[200:203], v[56:59], v[64:67]
  s_cmp_gt_i32 s75, 50
  s_cbranch_scc1 L_pc20b
  s_cbranch_vccnz L_pc20
  s_cmp_gt_i32 s75, -60
  s_cbranch_scc1 L_pc20a
  s_waitcnt vmcnt(3)
L_pc20a:
  s_waitcnt vmcnt(4)
L_pc20:
  s_waitcnt vmcnt(5)
L_pc20b:
  s_waitcnt vmcnt(7)
  buffer_load_dwordx4 v[200:203], v46, s[44:47], s8 offen nt
  s_add_u32 s8, s8, 4096
  s_waitcnt lgkmcnt(0)
  v_readfirstlane_b32 s79, v123
  s_sub_u32 s76, s76, s79
  s_sub_u32 s76, s76, s78
  s_abs_i32 s77, s76
  s_cmp_gt_u32 s77, 100000
  s_cselect_b32 s75, 0, s76
  s_cmp_gt_i32 s75, 0
  s_cselect_b64 vcc, -1, 0
  s_add_u32 s78, s78, 118
  v_mfma_f32_16x16x32_bf16 v[64:67], v[204:207], v[60:63], v[64:67]
  s_cmp_gt_i32 s75, 50
  s_cbranch_scc1 L_pc21b
  s_cbranch_vccnz L_pc21
  s_cmp_gt_i32 s75, -60
  s_cbranch_scc1 L_pc21a
  s_waitcnt vmcnt(3)
L_pc21a:
  s_waitcnt vmcnt(4)
L_pc21:
  s_waitcnt vmcnt(5)
L_pc21b:
  s_waitcnt vmcnt(7)
  buffer_load_dwordx4 v[204:207], v46, s[44:47], s8 offen nt
  s_add_u32 s8, s8, 4096
  s_nop 5
  v_mov_b32_dpp v8, v64 quad_perm:[0,0,0,0] row_mask:0xf bank_mask:0xf
  v_add_f32_dpp v8, v65, v8 quad_perm:[1,1,1,1] row_mask:0xf bank_mask:0xf
  v_add_f32_dpp v8, v66, v8 quad_perm:[2,2,2,2] row_mask:0xf bank_mask:0xf
  v_add_f32_dpp v8, v67, v8 quad_perm:[3,3,3,3] row_mask:0xf bank_mask:0xf
  v_mov_b32 v76, v8
  v_mfma_f32_16x16x32_bf16 v[64:67], v[208:211], v[48:51], 0
  s_cmp_gt_i32 s75, 50
  s_cbranch_scc1 L_pc22b
  s_cbranch_vccnz L_pc22
  s_cmp_gt_i32 s75, -60
  s_cbranch_scc1 L_pc22a
  s_waitcnt vmcnt(3)
L_pc22a:
  s_waitcnt vmcnt(4)
L_pc22:
  s_waitcnt vmcnt(5)
L_pc22b:
  s_waitcnt vmcnt(7)
  buffer_load_dwordx4 v[208:211], v46, s[44:47], s8 offen nt
  s_add_u32 s8, s8, 4096
  v_mfma_f32_16x16x32_bf16 v[64:67], v[212:215], v[52:55], v[64:67]
  s_cmp_gt_i32 s75, 50
  s_cbranch_scc1 L_pc23b
  s_cbranch_vccnz L_pc23
  s_cmp_gt_i32 s75, -60
  s_cbranch_scc1 L_pc23a
  s_waitcnt vmcnt(3)
L_pc23a:
  s_waitcnt vmcnt(4)
L_pc23:
  s_waitcnt vmcnt(5)
L_pc23b:
  s_waitcnt vmcnt(7)
  buffer_load_dwordx4 v[212:215], v46, s[44:47], s8 offen nt
  s_add_u32 s8, s8, 4096
  v_mfma_f32_16x16x32_bf16 v[64:67], v[216:219], v[56:59], v[64:67]
  s_cmp_gt_i32 s75, 50
  s_cbranch_scc1 L_pc24b
  s_cbranch_vccnz L_pc24
  s_cmp_gt_i32 s75, -60
  s_cbranch_scc1 L_pc24a
  s_waitcnt vmcnt(3)
L_pc24a:
  s_waitcnt vmcnt(4)
L_pc24:
  s_waitcnt vmcnt(5)
L_pc24b:
  s_waitcnt vmcnt(7)
  buffer_load_dwordx4 v[216:219], v46, s[44:47], s8 offen nt
  s_add_u32 s8, s8, 4096
  v_mfma_f32_16x16x32_bf16 v[64:67], v[220:223], v[60:63], v[64:67]
  s_cmp_gt_i32 s75, 50
  s_cbranch_scc1 L_pc25b
  s_cbranch_vccnz L_pc25
  s_cmp_gt_i32 s75, -60
  s_cbranch_scc1 L_pc25a
  s_waitcnt vmcnt(3)
L_pc25a:
  s_waitcnt vmcnt(4)
L_pc25:
  s_waitcnt vmcnt(5)
L_pc25b:
  s_waitcnt vmcnt(7)
  buffer_load_dwordx4 v[220:223], v46, s[44:47], s8 offen nt
  s_add_u32 s8, s8, 4096
  s_nop 5
  v_mov_b32_dpp v8, v64 quad_perm:[0,0,0,0] row_mask:0xf bank_mask:0xf
  v_add_f32_dpp v8, v65, v8 quad_perm:[1,1,1,1] row_mask:0xf bank_mask:0xf
  v_add_f32_dpp v8, v66, v8 quad_perm:[2,2,2,2] row_mask:0xf bank_mask:0xf
  v_add_f32_dpp v8, v67, v8 quad_perm:[3,3,3,3] row_mask:0xf bank_mask:0xf
  v_cndmask_b32 v76, v76, v8, s[62:63]
  v_mfma_f32_16x16x32_bf16 v[64:67], v[224:227], v[48:51], 0
  s_cmp_gt_i32 s75, 50
  s_cbranch_scc1 L_pc26b
  s_cbranch_vccnz L_pc26
  s_cmp_gt_i32 s75, -60
  s_cbranch_scc1 L_pc26a
  s_waitcnt vmcnt(3)
L_pc26a:
  s_waitcnt vmcnt(4)
L_pc26:
  s_waitcnt vmcnt(5)
L_pc26b:
  s_waitcnt vmcnt(7)
  buffer_load_dwordx4 v[224:227], v46, s[44:47], s8 offen nt
  s_add_u32 s8, s8, 4096
  s_memrealtime s[76:77]
  ds_read_b32 v123, v122 offset:8
  v_mfma_f32_16x16x32_bf16 v[64:67], v[228:231], v[52:55], v[64:67]
  s_cmp_gt_i32 s75, 50
  s_cbranch_scc1 L_pc27b
  s_cbranch_vccnz L_pc27
  s_cmp_gt_i32 s75, -60
  s_cbranch_scc1 L_pc27a
  s_waitcnt vmcnt(3)
L_pc27a:
  s_waitcnt vmcnt(4)
L_pc27:
  s_waitcnt vmcnt(5)
L_pc27b:
  s_waitcnt vmcnt(7)
  buffer_load_dwordx4 v[228:231], v46, s[44:47], s8 offen nt
  s_add_u32 s8, s8, 4096
  v_mfma_f32_16x16x32_bf16 v[64:67], v[232:235], v[56:59], v[64:67]
  s_cmp_gt_i32 s75, 50
  s_cbranch_scc1 L_pc28b
  s_cbranch_vccnz L_pc28
  s_cmp_gt_i32 s75, -60
  s_cbranch_scc1 L_pc28a
  s_waitcnt vmcnt(3)
L_pc28a:
  s_waitcnt vmcnt(4)
L_pc28:
  s_waitcnt vmcnt(5)
L_pc28b:
  s_waitcnt vmcnt(7)
  buffer_load_dwordx4 v[232:235], v46, s[44:47], s8 offen nt
  s_add_u32 s8, s8, 4096
  s_waitcnt lgkmcnt(0)
  v_readfirstlane_b32 s79, v123
  s_sub_u32 s76, s76, s79
  s_sub_u32 s76, s76, s78
  s_abs_i32 s77, s76
  s_cmp_gt_u32 s77, 100000
  s_cselect_b32 s75, 0, s76
  s_cmp_gt_i32 s75, 0
  s_cselect_b64 vcc, -1, 0
  s_add_u32 s78, s78, 118
  v_mfma_f32_16x16x32_bf16 v[64:67], v[236:239], v[60:63], v[64:67]
  s_cmp_gt_i32 s75, 50
  s_cbranch_scc1 L_pc29b
  s_cbranch_vccnz L_pc29
  s_cmp_gt_i32 s75, -60
  s_cbranch_scc1 L_pc29a
  s_waitcnt vmcnt(3)
L_pc29a:
  s_waitcnt vmcnt(4)
L_pc29:
  s_waitcnt vmcnt(5)
L_pc29b:
  s_waitcnt vmcnt(7)
  buffer_load_dwordx4 v[236:239], v46, s[44:47], s8 offen nt
  s_add_u32 s8, s8, 4096
  s_nop 5
  v_mov_b32_dpp v8, v64 quad_perm:[0,0,0,0] row_mask:0xf bank_mask:0xf
  v_add_f32_dpp v8, v65, v8 quad_perm:[1,1,1,1] row_mask:0xf bank_mask:0xf
  v_add_f32_dpp v8, v66, v8 quad_perm:[2,2,2,2] row_mask:0xf bank_mask:0xf
  v_add_f32_dpp v8, v67, v8 quad_perm:[3,3,3,3] row_mask:0xf bank_mask:0xf
  v_cndmask_b32 v76, v76, v8, s[64:65]
  v_mfma_f32_16x16x32_bf16 v[64:67], v[240:243], v[48:51], 0
  s_cmp_gt_i32 s75, 50
  s_cbranch_scc1 L_pc30b
  s_cbranch_vccnz L_pc30
  s_cmp_gt_i32 s75, -60
  s_cbranch_scc1 L_pc30a
  s_waitcnt vmcnt(3)
L_pc30a:
  s_waitcnt vmcnt(4)
L_pc30:
  s_waitcnt vmcnt(5)
L_pc30b:
  s_waitcnt vmcnt(7)
  buffer_load_dwordx4 v[240:243], v46, s[44:47], s8 offen nt
  s_add_u32 s8, s8, 4096
  v_mfma_f32_16x16x32_bf16 v[64:67], v[244:247], v[52:55], v[64:67]
  s_cmp_gt_i32 s75, 50
  s_cbranch_scc1 L_pc31b
  s_cbranch_vccnz L_pc31
  s_cmp_gt_i32 s75, -60
  s_cbranch_scc1 L_pc31a
  s_waitcnt vmcnt(3)
L_pc31a:
  s_waitcnt vmcnt(4)
L_pc31:
  s_waitcnt vmcnt(5)
L_pc31b:
  s_waitcnt vmcnt(7)
  buffer_load_dwordx4 v[244:247], v46, s[44:47], s8 offen nt
  s_add_u32 s8, s8, 4096
  v_mfma_f32_16x16x32_bf16 v[64:67], v[248:251], v[56:59], v[64:67]
  s_cmp_gt_i32 s75, 50
  s_cbranch_scc1 L_pc32b
  s_cbranch_vccnz L_pc32
  s_cmp_gt_i32 s75, -60
  s_cbranch_scc1 L_pc32a
  s_waitcnt vmcnt(3)
L_pc32a:
  s_waitcnt vmcnt(4)
L_pc32:
  s_waitcnt vmcnt(5)
L_pc32b:
  s_waitcnt vmcnt(7)
  buffer_load_dwordx4 v[248:251], v46, s[44:47], s8 offen nt
  s_add_u32 s8, s8, 4096
  v_mfma_f32_16x16x32_bf16 v[64:67], v[252:255], v[60:63], v[64:67]
  s_cmp_gt_i32 s75, 50
  s_cbranch_scc1 L_pc33b
  s_cbranch_vccnz L_pc33
  s_cmp_gt_i32 s75, -60
  s_cbranch_scc1 L_pc33a
  s_waitcnt vmcnt(3)
L_pc33a:
  s_waitcnt vmcnt(4)
L_pc33:
  s_waitcnt vmcnt(5)
L_pc33b:
  s_waitcnt vmcnt(7)
  buffer_load_dwordx4 v[252:255], v46, s[44:47], s8 offen nt
  s_add_u32 s8, s8, 4096
  s_nop 5
  v_mov_b32_dpp v8, v64 quad_perm:[0,0,0,0] row_mask:0xf bank_mask:0xf
  v_add_f32_dpp v8, v65, v8 quad_perm:[1,1,1,1] row_mask:0xf bank_mask:0xf
  v_add_f32_dpp v8, v66, v8 quad_perm:[2,2,2,2] row_mask:0xf bank_mask:0xf
  v_add_f32_dpp v8, v67, v8 quad_perm:[3,3,3,3] row_mask:0xf bank_mask:0xf
  v_cndmask_b32 v76, v76, v8, s[66:67]
  v_cvt_pk_bf16_f32 v76, v76, v76
  v_lshlrev_b32 v76, 16, v76
  v_mul_f32 v76, s12, v76
  v_cvt_pk_bf16_f32 v76, v76, v76
  v_lshlrev_b32 v76, 16, v76
  v_mov_b32 v68, v69
  v_mov_b32 v69, v70
  v_mov_b32 v70, v71
  v_mov_b32 v71, v72
  v_mov_b32 v72, v73
  v_mov_b32 v73, v74
  v_mov_b32 v74, v75
  v_mov_b32 v75, v76
  s_add_u32 s9, s9, 1
  s_cmp_lt_u32 s9, 4
  s_cbranch_scc1 L_kloop
  v_max3_f32 v8, v68, v69, v70
  v_max3_f32 v8, v8, v71, v72
  v_max3_f32 v8, v8, v73, v74
  v_max_f32 v8, v8, v75
  s_nop 1
  v_max_f32_dpp v8, v8, v8 row_shr:1 row_mask:0xf bank_mask:0xf
  s_nop 1
  v_max_f32_dpp v8, v8, v8 row_shr:2 row_mask:0xf bank_mask:0xf
  s_nop 1
  v_max_f32_dpp v8, v8, v8 row_shr:4 row_mask:0xf bank_mask:0xf
  s_nop 1
  v_max_f32_dpp v8, v8, v8 row_shr:8 row_mask:0xf bank_mask:0xf
  s_nop 1
  v_max_f32_dpp v8, v8, v8 row_bcast:15 row_mask:0xa bank_mask:0xf
  s_nop 1
  v_max_f32_dpp v8, v8, v8 row_bcast:31 row_mask:0xc bank_mask:0xf
  s_nop 1
  v_readlane_b32 s13, v8, 63
  s_mov_b32 s12, 1069066811
  v_mov_b32 v78, 0
  v_mov_b32 v24, 0
  v_mov_b32 v25, 0
  v_mov_b32 v26, 0
  v_mov_b32 v27, 0
  s_mov_b32 s9, 0
L_vloop:
  v_subrev_f32 v8, s13, v68
  v_mul_f32 v8, s12, v8
  v_exp_f32 v8, v8
  v_mov_b32 v68, v69
  v_mov_b32 v69, v70
  v_mov_b32 v70, v71
  v_mov_b32 v71, v72
  v_mov_b32 v72, v73
  v_mov_b32 v73, v74
  v_mov_b32 v74, v75
  v_add_f32 v78, v78, v8
  v_cvt_pk_bf16_f32 v77, v8, v8
  s_nop 1
  v_and_b32_dpp v16, v77, v4 row_newbcast:0 row_mask:0xf bank_mask:0xf
  v_and_b32_dpp v17, v77, v5 row_newbcast:0 row_mask:0xf bank_mask:0xf
  v_and_b32_dpp v18, v77, v6 row_newbcast:0 row_mask:0xf bank_mask:0xf
  v_and_b32_dpp v19, v77, v7 row_newbcast:0 row_mask:0xf bank_mask:0xf
  s_nop 1
  v_mfma_f32_16x16x32_bf16 v[24:27], v[16:19], v[128:131], v[24:27]
  s_cmp_gt_i32 s75, 50
  s_cbranch_scc1 L_pc34b
  s_cbranch_vccnz L_pc34
  s_cmp_gt_i32 s75, -60
  s_cbranch_scc1 L_pc34a
  s_waitcnt vmcnt(3)
L_pc34a:
  s_waitcnt vmcnt(4)
L_pc34:
  s_waitcnt vmcnt(5)
L_pc34b:
  s_waitcnt vmcnt(7)
  buffer_load_dwordx4 v[128:131], v46, s[44:47], s8 offen nt
  s_add_u32 s8, s8, 4096
  s_memrealtime s[76:77]
  ds_read_b32 v123, v122 offset:8
  v_and_b32_dpp v20, v77, v4 row_newbcast:4 row_mask:0xf bank_mask:0xf
  v_and_b32_dpp v21, v77, v5 row_newbcast:4 row_mask:0xf bank_mask:0xf
  v_and_b32_dpp v22, v77, v6 row_newbcast:4 row_mask:0xf bank_mask:0xf
  v_and_b32_dpp v23, v77, v7 row_newbcast:4 row_mask:0xf bank_mask:0xf
  s_nop 1
  v_mfma_f32_16x16x32_bf16 v[24:27], v[20:23], v[132:135], v[24:27]
  s_cmp_gt_i32 s75, 50
  s_cbranch_scc1 L_pc35b
  s_cbranch_vccnz L_pc35
  s_cmp_gt_i32 s75, -60
  s_cbranch_scc1 L_pc35a
  s_waitcnt vmcnt(3)
L_pc35a:
  s_waitcnt vmcnt(4)
L_pc35:
  s_waitcnt vmcnt(5)
L_pc35b:
  s_waitcnt vmcnt(7)
  buffer_load_dwordx4 v[132:135], v46, s[44:47], s8 offen nt
  s_add_u32 s8, s8, 4096
  v_and_b32_dpp v16, v77, v4 row_newbcast:8 row_mask:0xf bank_mask:0xf
  v_and_b32_dpp v17, v77, v5 row_newbcast:8 row_mask:0xf bank_mask:0xf
  v_and_b32_dpp v18, v77, v6 row_newbcast:8 row_mask:0xf bank_mask:0xf
  v_and_b32_dpp v19, v77, v7 row_newbcast:8 row_mask:0xf bank_mask:0xf
  s_nop 1
  v_mfma_f32_16x16x32_bf16 v[24:27], v[16:19], v[136:139], v[24:27]
  s_cmp_gt_i32 s75, 50
  s_cbranch_scc1 L_pc36b
  s_cbranch_vccnz L_pc36
  s_cmp_gt_i32 s75, -60
  s_cbranch_scc1 L_pc36a
  s_waitcnt vmcnt(3)
L_pc36a:
  s_waitcnt vmcnt(4)
L_pc36:
  s_waitcnt vmcnt(5)
L_pc36b:
  s_waitcnt vmcnt(7)
  buffer_load_dwordx4 v[136:139], v46, s[44:47], s8 offen nt
  s_add_u32 s8, s8, 4096
  s_waitcnt lgkmcnt(0)
  v_readfirstlane_b32 s79, v123
  s_cmp_lg_u32 s3, 0
  s_cbranch_scc1 L_ck37
  v_mov_b32 v120, s76
  v_add_u32 v121, 1, v121
  v_lshl_add_u32 v119, v121, 2, v122
  ds_write_b32 v119, v120 offset:28
  ds_write_b64 v122, v[120:121] offset:16
L_ck37:
  s_sub_u32 s76, s76, s79
  s_sub_u32 s76, s76, s78
  s_abs_i32 s77, s76
  s_cmp_gt_u32 s77, 100000
  s_cselect_b32 s75, 0, s76
  s_cmp_gt_i32 s75, 0
  s_cselect_b64 vcc, -1, 0
  s_add_u32 s78, s78, 109
  v_and_b32_dpp v20, v77, v4 row_newbcast:12 row_mask:0xf bank_mask:0xf
  v_and_b32_dpp v21, v77, v5 row_newbcast:12 row_mask:0xf bank_mask:0xf
  v_and_b32_dpp v22, v77, v6 row_newbcast:12 row_mask:0xf bank_mask:0xf
  v_and_b32_dpp v23, v77, v7 row_newbcast:12 row_mask:0xf bank_mask:0xf
  s_nop 1
  v_mfma_f32_16x16x32_bf16 v[24:27], v[20:23], v[140:143], v[24:27]
  s_cmp_gt_i32 s75, 50
  s_cbranch_scc1 L_pc38b
  s_cbranch_vccnz L_pc38
  s_cmp_gt_i32 s75, -60
  s_cbranch_scc1 L_pc38a
  s_waitcnt vmcnt(3)
L_pc38a:
  s_waitcnt vmcnt(4)
L_pc38:
  s_waitcnt vmcnt(5)
L_pc38b:
  s_waitcnt vmcnt(7)
  buffer_load_dwordx4 v[140:143], v46, s[44:47], s8 offen nt
  s_add_u32 s8, s8, 4096
  v_and_b32_dpp v16, v77, v4 row_newbcast:1 row_mask:0xf bank_mask:0xf
  v_and_b32_dpp v17, v77, v5 row_newbcast:1 row_mask:0xf bank_mask:0xf
  v_and_b32_dpp v18, v77, v6 row_newbcast:1 row_mask:0xf bank_mask:0xf
  v_and_b32_dpp v19, v77, v7 row_newbcast:1 row_mask:0xf bank_mask:0xf
  s_nop 1
  v_mfma_f32_16x16x32_bf16 v[24:27], v[16:19], v[144:147], v[24:27]
  s_cmp_gt_i32 s75, 50
  s_cbranch_scc1 L_pc39b
  s_cbranch_vccnz L_pc39
  s_cmp_gt_i32 s75, -60
  s_cbranch_scc1 L_pc39a
  s_waitcnt vmcnt(3)
L_pc39a:
  s_waitcnt vmcnt(4)
L_pc39:
  s_waitcnt vmcnt(5)
L_pc39b:
  s_waitcnt vmcnt(7)
  buffer_load_dwordx4 v[144:147], v46, s[44:47], s8 offen nt
  s_add_u32 s8, s8, 4096
  v_and_b32_dpp v20, v77, v4 row_newbcast:5 row_mask:0xf bank_mask:0xf
  v_and_b32_dpp v21, v77, v5 row_newbcast:5 row_mask:0xf bank_mask:0xf
  v_and_b32_dpp v22, v77, v6 row_newbcast:5 row_mask:0xf bank_mask:0xf
  v_and_b32_dpp v23, v77, v7 row_newbcast:5 row_mask:0xf bank_mask:0xf
  s_nop 1
  v_mfma_f32_16x16x32_bf16 v[24:27], v[20:23], v[148:151], v[24:27]
  s_cmp_gt_i32 s75, 50
  s_cbranch_scc1 L_pc40b
  s_cbranch_vccnz L_pc40
  s_cmp_gt_i32 s75, -60
  s_cbranch_scc1 L_pc40a
  s_waitcnt vmcnt(3)
L_pc40a:
  s_waitcnt vmcnt(4)
L_pc40:
  s_waitcnt vmcnt(5)
L_pc40b:
  s_waitcnt vmcnt(7)
  buffer_load_dwordx4 v[148:151], v46, s[44:47], s8 offen nt
  s_add_u32 s8, s8, 4096
  v_and_b32_dpp v16, v77, v4 row_newbcast:9 row_mask:0xf bank_mask:0xf
  v_and_b32_dpp v17, v77, v5 row_newbcast:9 row_mask:0xf bank_mask:0xf
  v_and_b32_dpp v18, v77, v6 row_newbcast:9 row_mask:0xf bank_mask:0xf
  v_and_b32_dpp v19, v77, v7 row_newbcast:9 row_mask:0xf bank_mask:0xf
  s_nop 1
  v_mfma_f32_16x16x32_bf16 v[24:27], v[16:19], v[152:155], v[24:27]
  s_cmp_gt_i32 s75, 50
  s_cbranch_scc1 L_pc41b
  s_cbranch_vccnz L_pc41
  s_cmp_gt_i32 s75, -60
  s_cbranch_scc1 L_pc41a
  s_waitcnt vmcnt(3)
L_pc41a:
  s_waitcnt vmcnt(4)
L_pc41:
  s_waitcnt vmcnt(5)
L_pc41b:
  s_waitcnt vmcnt(7)
  buffer_load_dwordx4 v[152:155], v46, s[44:47], s8 offen nt
  s_add_u32 s8, s8, 4096
  v_and_b32_dpp v20, v77, v4 row_newbcast:13 row_mask:0xf bank_mask:0xf
  v_and_b32_dpp v21, v77, v5 row_newbcast:13 row_mask:0xf bank_mask:0xf
  v_and_b32_dpp v22, v77, v6 row_newbcast:13 row_mask:0xf bank_mask:0xf
  v_and_b32_dpp v23, v77, v7 row_newbcast:13 row_mask:0xf bank_mask:0xf
  s_nop 1
  v_mfma_f32_16x16x32_bf16 v[24:27], v[20:23], v[156:159], v[24:27]
  s_cmp_gt_i32 s75, 50
  s_cbranch_scc1 L_pc42b
  s_cbranch_vccnz L_pc42
  s_cmp_gt_i32 s75, -60
  s_cbranch_scc1 L_pc42a
  s_waitcnt vmcnt(3)
L_pc42a:
  s_waitcnt vmcnt(4)
L_pc42:
  s_waitcnt vmcnt(5)
L_pc42b:
  s_waitcnt vmcnt(7)
  buffer_load_dwordx4 v[156:159], v46, s[44:47], s8 offen nt
  s_add_u32 s8, s8, 4096
  v_and_b32_dpp v16, v77, v4 row_newbcast:2 row_mask:0xf bank_mask:0xf
  v_and_b32_dpp v17, v77, v5 row_newbcast:2 row_mask:0xf bank_mask:0xf
  v_and_b32_dpp v18, v77, v6 row_newbcast:2 row_mask:0xf bank_mask:0xf
  v_and_b32_dpp v19, v77, v7 row_newbcast:2 row_mask:0xf bank_mask:0xf
  s_nop 1
  v_mfma_f32_16x16x32_bf16 v[24:27], v[16:19], v[160:163], v[24:27]
  s_cmp_gt_i32 s75, 50
  s_cbranch_scc1 L_pc43b
  s_cbranch_vccnz L_pc43
  s_cmp_gt_i32 s75, -60
  s_cbranch_scc1 L_pc43a
  s_waitcnt vmcnt(3)
L_pc43a:
  s_waitcnt vmcnt(4)
L_pc43:
  s_waitcnt vmcnt(5)
L_pc43b:
  s_waitcnt vmcnt(7)
  buffer_load_dwordx4 v[160:163], v46, s[44:47], s8 offen nt
  s_add_u32 s8, s8, 4096
  s_memrealtime s[76:77]
  ds_read_b32 v123, v122 offset:8
  v_and_b32_dpp v20, v77, v4 row_newbcast:6 row_mask:0xf bank_mask:0xf
  v_and_b32_dpp v21, v77, v5 row_newbcast:6 row_mask:0xf bank_mask:0xf
  v_and_b32_dpp v22, v77, v6 row_newbcast:6 row_mask:0xf bank_mask:0xf
  v_and_b32_dpp v23, v77, v7 row_newbcast:6 row_mask:0xf bank_mask:0xf
  s_nop 1
  v_mfma_f32_16x16x32_bf16 v[24:27], v[20:23], v[164:167], v[24:27]
  s_cmp_gt_i32 s75, 50
  s_cbranch_scc1 L_pc44b
  s_cbranch_vccnz L_pc44
  s_cmp_gt_i32 s75, -60
  s_cbranch_scc1 L_pc44a
  s_waitcnt vmcnt(3)
L_pc44a:
  s_waitcnt vmcnt(4)
L_pc44:
  s_waitcnt vmcnt(5)
L_pc44b:
  s_waitcnt vmcnt(7)
  buffer_load_dwordx4 v[164:167], v46, s[44:47], s8 offen nt
  s_add_u32 s8, s8, 4096
  v_and_b32_dpp v16, v77, v4 row_newbcast:10 row_mask:0xf bank_mask:0xf
  v_and_b32_dpp v17, v77, v5 row_newbcast:10 row_mask:0xf bank_mask:0xf
  v_and_b32_dpp v18, v77, v6 row_newbcast:10 row_mask:0xf bank_mask:0xf
  v_and_b32_dpp v19, v77, v7 row_newbcast:10 row_mask:0xf bank_mask:0xf
  s_nop 1
  v_mfma_f32_16x16x32_bf16 v[24:27], v[16:19], v[168:171], v[24:27]
  s_cmp_gt_i32 s75, 50
  s_cbranch_scc1 L_pc45b
  s_cbranch_vccnz L_pc45
  s_cmp_gt_i32 s75, -60
  s_cbranch_scc1 L_pc45a
  s_waitcnt vmcnt(3)
L_pc45a:
  s_waitcnt vmcnt(4)
L_pc45:
  s_waitcnt vmcnt(5)
L_pc45b:
  s_waitcnt vmcnt(7)
  buffer_load_dwordx4 v[168:171], v46, s[44:47], s8 offen nt
  s_add_u32 s8, s8, 4096
  s_waitcnt lgkmcnt(0)
  v_readfirstlane_b32 s79, v123
  s_sub_u32 s76, s76, s79
  s_sub_u32 s76, s76, s78
  s_abs_i32 s77, s76
  s_cmp_gt_u32 s77, 100000
  s_cselect_b32 s75, 0, s76
  s_cmp_gt_i32 s75, 0
  s_cselect_b64 vcc, -1, 0
  s_add_u32 s78, s78, 110
  v_and_b32_dpp v20, v77, v4 row_newbcast:14 row_mask:0xf bank_mask:0xf
  v_and_b32_dpp v21, v77, v5 row_newbcast:14 row_mask:0xf bank_mask:0xf
  v_and_b32_dpp v22, v77, v6 row_newbcast:14 row_mask:0xf bank_mask:0xf
  v_and_b32_dpp v23, v77, v7 row_newbcast:14 row_mask:0xf bank_mask:0xf
  s_nop 1
  v_mfma_f32_16x16x32_bf16 v[24:27], v[20:23], v[172:175], v[24:27]
  s_cmp_gt_i32 s75, 50
  s_cbranch_scc1 L_pc46b
  s_cbranch_vccnz L_pc46
  s_cmp_gt_i32 s75, -60
  s_cbranch_scc1 L_pc46a
  s_waitcnt vmcnt(3)
L_pc46a:
  s_waitcnt vmcnt(4)
L_pc46:
  s_waitcnt vmcnt(5)
L_pc46b:
  s_waitcnt vmcnt(7)
  buffer_load_dwordx4 v[172:175], v46, s[44:47], s8 offen nt
  s_add_u32 s8, s8, 4096
  v_and_b32_dpp v16, v77, v4 row_newbcast:3 row_mask:0xf bank_mask:0xf
  v_and_b32_dpp v17, v77, v5 row_newbcast:3 row_mask:0xf bank_mask:0xf
  v_and_b32_dpp v18, v77, v6 row_newbcast:3 row_mask:0xf bank_mask:0xf
  v_and_b32_dpp v19, v77, v7 row_newbcast:3 row_mask:0xf bank_mask:0xf
  s_nop 1
  v_mfma_f32_16x16x32_bf16 v[24:27], v[16:19], v[176:179], v[24:27]
  s_cmp_gt_i32 s75, 50
  s_cbranch_scc1 L_pc47b
  s_cbranch_vccnz L_pc47
  s_cmp_gt_i32 s75, -60
  s_cbranch_scc1 L_pc47a
  s_waitcnt vmcnt(3)
L_pc47a:
  s_waitcnt vmcnt(4)
L_pc47:
  s_waitcnt vmcnt(5)
L_pc47b:
  s_waitcnt vmcnt(7)
  buffer_load_dwordx4 v[176:179], v46, s[44:47], s8 offen nt
  s_add_u32 s8, s8, 4096
  v_and_b32_dpp v20, v77, v4 row_newbcast:7 row_mask:0xf bank_mask:0xf
  v_and_b32_dpp v21, v77, v5 row_newbcast:7 row_mask:0xf bank_mask:0xf
  v_and_b32_dpp v22, v77, v6 row_newbcast:7 row_mask:0xf bank_mask:0xf
  v_and_b32_dpp v23, v77, v7 row_newbcast:7 row_mask:0xf bank_mask:0xf
  s_nop 1
  v_mfma_f32_16x16x32_bf16 v[24:27], v[20:23], v[180:183], v[24:27]
  s_cmp_gt_i32 s75, 50
  s_cbranch_scc1 L_pc48b
  s_cbranch_vccnz L_pc48
  s_cmp_gt_i32 s75, -60
  s_cbranch_scc1 L_pc48a
  s_waitcnt vmcnt(3)
L_pc48a:
  s_waitcnt vmcnt(4)
L_pc48:
  s_waitcnt vmcnt(5)
L_pc48b:
  s_waitcnt vmcnt(7)
  buffer_load_dwordx4 v[180:183], v46, s[44:47], s8 offen nt
  s_add_u32 s8, s8, 4096
  v_and_b32_dpp v16, v77, v4 row_newbcast:11 row_mask:0xf bank_mask:0xf
  v_and_b32_dpp v17, v77, v5 row_newbcast:11 row_mask:0xf bank_mask:0xf
  v_and_b32_dpp v18, v77, v6 row_newbcast:11 row_mask:0xf bank_mask:0xf
  v_and_b32_dpp v19, v77, v7 row_newbcast:11 row_mask:0xf bank_mask:0xf
  s_nop 1
  v_mfma_f32_16x16x32_bf16 v[24:27], v[16:19], v[184:187], v[24:27]
  s_cmp_gt_i32 s75, 50
  s_cbranch_scc1 L_pc49b
  s_cbranch_vccnz L_pc49
  s_cmp_gt_i32 s75, -60
  s_cbranch_scc1 L_pc49a
  s_waitcnt vmcnt(3)
L_pc49a:
  s_waitcnt vmcnt(4)
L_pc49:
  s_waitcnt vmcnt(5)
L_pc49b:
  s_waitcnt vmcnt(7)
  buffer_load_dwordx4 v[184:187], v46, s[44:47], s8 offen nt
  s_add_u32 s8, s8, 4096
  v_and_b32_dpp v20, v77, v4 row_newbcast:15 row_mask:0xf bank_mask:0xf
  v_and_b32_dpp v21, v77, v5 row_newbcast:15 row_mask:0xf bank_mask:0xf
  v_and_b32_dpp v22, v77, v6 row_newbcast:15 row_mask:0xf bank_mask:0xf
  v_and_b32_dpp v23, v77, v7 row_newbcast:15 row_mask:0xf bank_mask:0xf
  s_nop 1
  v_mfma_f32_16x16x32_bf16 v[24:27], v[20:23], v[188:191], v[24:27]
  s_cmp_gt_i32 s75, 50
  s_cbranch_scc1 L_pc50b
  s_cbranch_vccnz L_pc50
  s_cmp_gt_i32 s75, -60
  s_cbranch_scc1 L_pc50a
  s_waitcnt vmcnt(3)
L_pc50a:
  s_waitcnt vmcnt(4)
L_pc50:
  s_waitcnt vmcnt(5)
L_pc50b:
  s_waitcnt vmcnt(7)
  buffer_load_dwordx4 v[188:191], v46, s[44:47], s8 offen nt
  s_add_u32 s8, s8, 4096
  v_subrev_f32 v8, s13, v68
  v_mul_f32 v8, s12, v8
  v_exp_f32 v8, v8
  v_mov_b32 v68, v69
  v_mov_b32 v69, v70
  v_mov_b32 v70, v71
  v_mov_b32 v71, v72
  v_mov_b32 v72, v73
  v_mov_b32 v73, v74
  v_mov_b32 v74, v75
  v_add_f32 v78, v78, v8
  v_cvt_pk_bf16_f32 v77, v8, v8
  s_nop 1
  v_and_b32_dpp v16, v77, v4 row_newbcast:0 row_mask:0xf bank_mask:0xf
  v_and_b32_dpp v17, v77, v5 row_newbcast:0 row_mask:0xf bank_mask:0xf
  v_and_b32_dpp v18, v77, v6 row_newbcast:0 row_mask:0xf bank_mask:0xf
  v_and_b32_dpp v19, v77, v7 row_newbcast:0 row_mask:0xf bank_mask:0xf
  s_nop 1
  v_mfma_f32_16x16x32_bf16 v[24:27], v[16:19], v[192:195], v[24:27]
  s_cmp_gt_i32 s75, 50
  s_cbranch_scc1 L_pc51b
  s_cbranch_vccnz L_pc51
  s_cmp_gt_i32 s75, -60
  s_cbranch_scc1 L_pc51a
  s_waitcnt vmcnt(3)
L_pc51a:
  s_waitcnt vmcnt(4)
L_pc51:
  s_waitcnt vmcnt(5)
L_pc51b:
  s_waitcnt vmcnt(7)
  buffer_load_dwordx4 v[192:195], v46, s[44:47], s8 offen nt
  s_add_u32 s8, s8, 4096
  s_memrealtime s[76:77]
  ds_read_b32 v123, v122 offset:8
  v_and_b32_dpp v20, v77, v4 row_newbcast:4 row_mask:0xf bank_mask:0xf
  v_and_b32_dpp v21, v77, v5 row_newbcast:4 row_mask:0xf bank_mask:0xf
  v_and_b32_dpp v22, v77, v6 row_newbcast:4 row_mask:0xf bank_mask:0xf
  v_and_b32_dpp v23, v77, v7 row_newbcast:4 row_mask:0xf bank_mask:0xf
  s_nop 1
  v_mfma_f32_16x16x32_bf16 v[24:27], v[20:23], v[196:199], v[24:27]
  s_cmp_gt_i32 s75, 50
  s_cbranch_scc1 L_pc52b
  s_cbranch_vccnz L_pc52
  s_cmp_gt_i32 s75, -60
  s_cbranch_scc1 L_pc52a
  s_waitcnt vmcnt(3)
L_pc52a:
  s_waitcnt vmcnt(4)
L_pc52:
  s_waitcnt vmcnt(5)
L_pc52b:
  s_waitcnt vmcnt(7)
  buffer_load_dwordx4 v[196:199], v46, s[44:47], s8 offen nt
  s_add_u32 s8, s8, 4096
  v_and_b32_dpp v16, v77, v4 row_newbcast:8 row_mask:0xf bank_mask:0xf
  v_and_b32_dpp v17, v77, v5 row_newbcast:8 row_mask:0xf bank_mask:0xf
  v_and_b32_dpp v18, v77, v6 row_newbcast:8 row_mask:0xf bank_mask:0xf
  v_and_b32_dpp v19, v77, v7 row_newbcast:8 row_mask:0xf bank_mask:0xf
  s_nop 1
  v_mfma_f32_16x16x32_bf16 v[24:27], v[16:19], v[200:203], v[24:27]
  s_cmp_gt_i32 s75, 50
  s_cbranch_scc1 L_pc53b
  s_cbranch_vccnz L_pc53
  s_cmp_gt_i32 s75, -60
  s_cbranch_scc1 L_pc53a
  s_waitcnt vmcnt(3)
L_pc53a:
  s_waitcnt vmcnt(4)
L_pc53:
  s_waitcnt vmcnt(5)
L_pc53b:
  s_waitcnt vmcnt(7)
  buffer_load_dwordx4 v[200:203], v46, s[44:47], s8 offen nt
  s_add_u32 s8, s8, 4096
  s_waitcnt lgkmcnt(0)
  v_readfirstlane_b32 s79, v123
  s_sub_u32 s76, s76, s79
  s_sub_u32 s76, s76, s78
  s_abs_i32 s77, s76
  s_cmp_gt_u32 s77, 100000
  s_cselect_b32 s75, 0, s76
  s_cmp_gt_i32 s75, 0
  s_cselect_b64 vcc, -1, 0
  s_add_u32 s78, s78, 109
  v_and_b32_dpp v20, v77, v4 row_newbcast:12 row_mask:0xf bank_mask:0xf
  v_and_b32_dpp v21, v77, v5 row_newbcast:12 row_mask:0xf bank_mask:0xf
  v_and_b32_dpp v22, v77, v6 row_newbcast:12 row_mask:0xf bank_mask:0xf
  v_and_b32_dpp v23, v77, v7 row_newbcast:12 row_mask:0xf bank_mask:0xf
  s_nop 1
  v_mfma_f32_16x16x32_bf16 v[24:27], v[20:23], v[204:207], v[24:27]
  s_cmp_gt_i32 s75, 50
  s_cbranch_scc1 L_pc54b
  s_cbranch_vccnz L_pc54
  s_cmp_gt_i32 s75, -60
  s_cbranch_scc1 L_pc54a
  s_waitcnt vmcnt(3)
L_pc54a:
  s_waitcnt vmcnt(4)
L_pc54:
  s_waitcnt vmcnt(5)
L_pc54b:
  s_waitcnt vmcnt(7)
  buffer_load_dwordx4 v[204:207], v46, s[44:47], s8 offen nt
  s_add_u32 s8, s8, 4096
  v_and_b32_dpp v16, v77, v4 row_newbcast:1 row_mask:0xf bank_mask:0xf
  v_and_b32_dpp v17, v77, v5 row_newbcast:1 row_mask:0xf bank_mask:0xf
  v_and_b32_dpp v18, v77, v6 row_newbcast:1 row_mask:0xf bank_mask:0xf
  v_and_b32_dpp v19, v77, v7 row_newbcast:1 row_mask:0xf bank_mask:0xf
  s_nop 1
  v_mfma_f32_16x16x32_bf16 v[24:27], v[16:19], v[208:211], v[24:27]
  s_cmp_gt_i32 s75, 50
  s_cbranch_scc1 L_pc55b
  s_cbranch_vccnz L_pc55
  s_cmp_gt_i32 s75, -60
  s_cbranch_scc1 L_pc55a
  s_waitcnt vmcnt(3)
L_pc55a:
  s_waitcnt vmcnt(4)
L_pc55:
  s_waitcnt vmcnt(5)
L_pc55b:
  s_waitcnt vmcnt(7)
  buffer_load_dwordx4 v[208:211], v46, s[44:47], s8 offen nt
  s_add_u32 s8, s8, 4096
  v_and_b32_dpp v20, v77, v4 row_newbcast:5 row_mask:0xf bank_mask:0xf
  v_and_b32_dpp v21, v77, v5 row_newbcast:5 row_mask:0xf bank_mask:0xf
  v_and_b32_dpp v22, v77, v6 row_newbcast:5 row_mask:0xf bank_mask:0xf
  v_and_b32_dpp v23, v77, v7 row_newbcast:5 row_mask:0xf bank_mask:0xf
  s_nop 1
  v_mfma_f32_16x16x32_bf16 v[24:27], v[20:23], v[212:215], v[24:27]
  s_cmp_gt_i32 s75, 50
  s_cbranch_scc1 L_pc56b
  s_cbranch_vccnz L_pc56
  s_cmp_gt_i32 s75, -60
  s_cbranch_scc1 L_pc56a
  s_waitcnt vmcnt(3)
L_pc56a:
  s_waitcnt vmcnt(4)
L_pc56:
  s_waitcnt vmcnt(5)
L_pc56b:
  s_waitcnt vmcnt(7)
  buffer_load_dwordx4 v[212:215], v46, s[44:47], s8 offen nt
  s_add_u32 s8, s8, 4096
  v_and_b32_dpp v16, v77, v4 row_newbcast:9 row_mask:0xf bank_mask:0xf
  v_and_b32_dpp v17, v77, v5 row_newbcast:9 row_mask:0xf bank_mask:0xf
  v_and_b32_dpp v18, v77, v6 row_newbcast:9 row_mask:0xf bank_mask:0xf
  v_and_b32_dpp v19, v77, v7 row_newbcast:9 row_mask:0xf bank_mask:0xf
  s_nop 1
  v_mfma_f32_16x16x32_bf16 v[24:27], v[16:19], v[216:219], v[24:27]
  s_cmp_gt_i32 s75, 50
  s_cbranch_scc1 L_pc57b
  s_cbranch_vccnz L_pc57
  s_cmp_gt_i32 s75, -60
  s_cbranch_scc1 L_pc57a
  s_waitcnt vmcnt(3)
L_pc57a:
  s_waitcnt vmcnt(4)
L_pc57:
  s_waitcnt vmcnt(5)
L_pc57b:
  s_waitcnt vmcnt(7)
  buffer_load_dwordx4 v[216:219], v46, s[44:47], s8 offen nt
  s_add_u32 s8, s8, 4096
  v_and_b32_dpp v20, v77, v4 row_newbcast:13 row_mask:0xf bank_mask:0xf
  v_and_b32_dpp v21, v77, v5 row_newbcast:13 row_mask:0xf bank_mask:0xf
  v_and_b32_dpp v22, v77, v6 row_newbcast:13 row_mask:0xf bank_mask:0xf
  v_and_b32_dpp v23, v77, v7 row_newbcast:13 row_mask:0xf bank_mask:0xf
  s_nop 1
  v_mfma_f32_16x16x32_bf16 v[24:27], v[20:23], v[220:223], v[24:27]
  s_cmp_gt_i32 s75, 50
  s_cbranch_scc1 L_pc58b
  s_cbranch_vccnz L_pc58
  s_cmp_gt_i32 s75, -60
  s_cbranch_scc1 L_pc58a
  s_waitcnt vmcnt(3)
L_pc58a:
  s_waitcnt vmcnt(4)
L_pc58:
  s_waitcnt vmcnt(5)
L_pc58b:
  s_waitcnt vmcnt(7)
  buffer_load_dwordx4 v[220:223], v46, s[44:47], s8 offen nt
  s_add_u32 s8, s8, 4096
  s_cmp_eq_u32 s9, 2
  s_cselect_b32 s77, 100, 0
  s_sub_u32 s78, s78, s77
  v_and_b32_dpp v16, v77, v4 row_newbcast:2 row_mask:0xf bank_mask:0xf
  v_and_b32_dpp v17, v77, v5 row_newbcast:2 row_mask:0xf bank_mask:0xf
  v_and_b32_dpp v18, v77, v6 row_newbcast:2 row_mask:0xf bank_mask:0xf
  v_and_b32_dpp v19, v77, v7 row_newbcast:2 row_mask:0xf bank_mask:0xf
  s_nop 1
  v_mfma_f32_16x16x32_bf16 v[24:27], v[16:19], v[224:227], v[24:27]
  s_cmp_gt_i32 s75, 50
  s_cbranch_scc1 L_pc59b
  s_cbranch_vccnz L_pc59
  s_cmp_gt_i32 s75, -60
  s_cbranch_scc1 L_pc59a
  s_waitcnt vmcnt(3)
L_pc59a:
  s_waitcnt vmcnt(4)
L_pc59:
  s_waitcnt vmcnt(5)
L_pc59b:
  s_waitcnt vmcnt(7)
  buffer_load_dwordx4 v[224:227], v46, s[44:47], s8 offen nt
  s_add_u32 s8, s8, 4096
  s_memrealtime s[76:77]
  ds_read_b32 v123, v122 offset:8
  v_and_b32_dpp v20, v77, v4 row_newbcast:6 row_mask:0xf bank_mask:0xf
  v_and_b32_dpp v21, v77, v5 row_newbcast:6 row_mask:0xf bank_mask:0xf
  v_and_b32_dpp v22, v77, v6 row_newbcast:6 row_mask:0xf bank_mask:0xf
  v_and_b32_dpp v23, v77, v7 row_newbcast:6 row_mask:0xf bank_mask:0xf
  s_nop 1
  v_mfma_f32_16x16x32_bf16 v[24:27], v[20:23], v[228:231], v[24:27]
  s_cmp_gt_i32 s75, 50
  s_cbranch_scc1 L_pc60b
  s_cbranch_vccnz L_pc60
  s_cmp_gt_i32 s75, -60
  s_cbranch_scc1 L_pc60a
  s_waitcnt vmcnt(3)
L_pc60a:
  s_waitcnt vmcnt(4)
L_pc60:
  s_waitcnt vmcnt(5)
L_pc60b:
  s_waitcnt vmcnt(7)
  buffer_load_dwordx4 v[228:231], v46, s[44:47], s8 offen nt
  s_add_u32 s8, s8, 4096
  v_and_b32_dpp v16, v77, v4 row_newbcast:10 row_mask:0xf bank_mask:0xf
  v_and_b32_dpp v17, v77, v5 row_newbcast:10 row_mask:0xf bank_mask:0xf
  v_and_b32_dpp v18, v77, v6 row_newbcast:10 row_mask:0xf bank_mask:0xf
  v_and_b32_dpp v19, v77, v7 row_newbcast:10 row_mask:0xf bank_mask:0xf
  s_nop 1
  v_mfma_f32_16x16x32_bf16 v[24:27], v[16:19], v[232:235], v[24:27]
  s_cmp_gt_i32 s75, 50
  s_cbranch_scc1 L_pc61b
  s_cbranch_vccnz L_pc61
  s_cmp_gt_i32 s75, -60
  s_cbranch_scc1 L_pc61a
  s_waitcnt vmcnt(3)
L_pc61a:
  s_waitcnt vmcnt(4)
L_pc61:
  s_waitcnt vmcnt(5)
L_pc61b:
  s_waitcnt vmcnt(7)
  buffer_load_dwordx4 v[232:235], v46, s[44:47], s8 offen nt
  s_add_u32 s8, s8, 4096
  s_waitcnt lgkmcnt(0)
  v_readfirstlane_b32 s79, v123
  s_sub_u32 s76, s76, s79
  s_sub_u32 s76, s76, s78
  s_abs_i32 s77, s76
  s_cmp_gt_u32 s77, 100000
  s_cselect_b32 s75, 0, s76
  s_cmp_gt_i32 s75, 0
  s_cselect_b64 vcc, -1, 0
  s_add_u32 s78, s78, 110
  v_and_b32_dpp v20, v77, v4 row_newbcast:14 row_mask:0xf bank_mask:0xf
  v_and_b32_dpp v21, v77, v5 row_newbcast:14 row_mask:0xf bank_mask:0xf
  v_and_b32_dpp v22, v77, v6 row_newbcast:14 row_mask:0xf bank_mask:0xf
  v_and_b32_dpp v23, v77, v7 row_newbcast:14 row_mask:0xf bank_mask:0xf
  s_nop 1
  v_mfma_f32_16x16x32_bf16 v[24:27], v[20:23], v[236:239], v[24:27]
  s_cmp_gt_i32 s75, 50
  s_cbranch_scc1 L_pc62b
  s_cbranch_vccnz L_pc62
  s_cmp_gt_i32 s75, -60
  s_cbranch_scc1 L_pc62a
  s_waitcnt vmcnt(3)
L_pc62a:
  s_waitcnt vmcnt(4)
L_pc62:
  s_waitcnt vmcnt(5)
L_pc62b:
  s_waitcnt vmcnt(7)
  buffer_load_dwordx4 v[236:239], v46, s[44:47], s8 offen nt
  s_add_u32 s8, s8, 4096
  v_and_b32_dpp v16, v77, v4 row_newbcast:3 row_mask:0xf bank_mask:0xf
  v_and_b32_dpp v17, v77, v5 row_newbcast:3 row_mask:0xf bank_mask:0xf
  v_and_b32_dpp v18, v77, v6 row_newbcast:3 row_mask:0xf bank_mask:0xf
  v_and_b32_dpp v19, v77, v7 row_newbcast:3 row_mask:0xf bank_mask:0xf
  s_nop 1
  v_mfma_f32_16x16x32_bf16 v[24:27], v[16:19], v[240:243], v[24:27]
  s_cmp_gt_i32 s75, 50
  s_cbranch_scc1 L_pc63b
  s_cbranch_vccnz L_pc63
  s_cmp_gt_i32 s75, -60
  s_cbranch_scc1 L_pc63a
  s_waitcnt vmcnt(3)
L_pc63a:
  s_waitcnt vmcnt(4)
L_pc63:
  s_waitcnt vmcnt(5)
L_pc63b:
  s_waitcnt vmcnt(7)
  buffer_load_dwordx4 v[240:243], v46, s[44:47], s8 offen nt
  s_add_u32 s8, s8, 4096
  v_and_b32_dpp v20, v77, v4 row_newbcast:7 row_mask:0xf bank_mask:0xf
  v_and_b32_dpp v21, v77, v5 row_newbcast:7 row_mask:0xf bank_mask:0xf
  v_and_b32_dpp v22, v77, v6 row_newbcast:7 row_mask:0xf bank_mask:0xf
  v_and_b32_dpp v23, v77, v7 row_newbcast:7 row_mask:0xf bank_mask:0xf
  s_nop 1
  v_mfma_f32_16x16x32_bf16 v[24:27], v[20:23], v[244:247], v[24:27]
  s_cmp_gt_i32 s75, 50
  s_cbranch_scc1 L_pc64b
  s_cbranch_vccnz L_pc64
  s_cmp_gt_i32 s75, -60
  s_cbranch_scc1 L_pc64a
  s_waitcnt vmcnt(3)
L_pc64a:
  s_waitcnt vmcnt(4)
L_pc64:
  s_waitcnt vmcnt(5)
L_pc64b:
  s_waitcnt vmcnt(7)
  buffer_load_dwordx4 v[244:247], v46, s[44:47], s8 offen nt
  s_add_u32 s8, s8, 4096
  v_and_b32_dpp v16, v77, v4 row_newbcast:11 row_mask:0xf bank_mask:0xf
  v_and_b32_dpp v17, v77, v5 row_newbcast:11 row_mask:0xf bank_mask:0xf
  v_and_b32_dpp v18, v77, v6 row_newbcast:11 row_mask:0xf bank_mask:0xf
  v_and_b32_dpp v19, v77, v7 row_newbcast:11 row_mask:0xf bank_mask:0xf
  s_nop 1
  v_mfma_f32_16x16x32_bf16 v[24:27], v[16:19], v[248:251], v[24:27]
  s_cmp_gt_i32 s75, 50
  s_cbranch_scc1 L_pc65b
  s_cbranch_vccnz L_pc65
  s_cmp_gt_i32 s75, -60
  s_cbranch_scc1 L_pc65a
  s_waitcnt vmcnt(3)
L_pc65a:
  s_waitcnt vmcnt(4)
L_pc65:
  s_waitcnt vmcnt(5)
L_pc65b:
  s_waitcnt vmcnt(7)
  buffer_load_dwordx4 v[248:251], v46, s[44:47], s8 offen nt
  s_add_u32 s8, s8, 4096
  v_and_b32_dpp v20, v77, v4 row_newbcast:15 row_mask:0xf bank_mask:0xf
  v_and_b32_dpp v21, v77, v5 row_newbcast:15 row_mask:0xf bank_mask:0xf
  v_and_b32_dpp v22, v77, v6 row_newbcast:15 row_mask:0xf bank_mask:0xf
  v_and_b32_dpp v23, v77, v7 row_newbcast:15 row_mask:0xf bank_mask:0xf
  s_nop 1
  v_mfma_f32_16x16x32_bf16 v[24:27], v[20:23], v[252:255], v[24:27]
  s_cmp_gt_i32 s75, 50
  s_cbranch_scc1 L_pc66b
  s_cbranch_vccnz L_pc66
  s_cmp_gt_i32 s75, -60
  s_cbranch_scc1 L_pc66a
  s_waitcnt vmcnt(3)
L_pc66a:
  s_waitcnt vmcnt(4)
L_pc66:
  s_waitcnt vmcnt(5)
L_pc66b:
  s_waitcnt vmcnt(7)
  buffer_load_dwordx4 v[252:255], v46, s[44:47], s8 offen nt
  s_add_u32 s8, s8, 4096
  s_add_u32 s9, s9, 1
  s_cmp_lt_u32 s9, 3
  s_cbranch_scc1 L_vloop
  s_mul_i32 s8, s6, 20736
  s_lshl_b32 s10, s3, 9
  v_lshlrev_b32 v8, 5, v3
  v_lshl_add_u32 v8, v2, 4, v8
  v_add_u32 v82, s10, v8
  s_mul_i32 s10, s3, 576
  v_add_u32 v36, s10, v8
  s_lshl_b32 s10, s3, 3
  v_mov_b32 v83, s10
  v_mov_b32 v44, s13
  v_lshlrev_b32 v37, 2, v1
  s_and_b32 s10, s2, 0
  s_lshl_b32 s10, s10, 13
  s_add_u32 s64, s10, 5373952
  s_add_u32 s65, s10, 5376000
  s_add_u32 s66, s10, 5378048
  s_add_u32 s67, s10, 5380096
  s_cmp_eq_u32 s3, 3
  s_cselect_b32 s10, 144, 0
  s_cmp_lt_u32 s2, s10
  s_cselect_b32 s10, 0, 1073741824
  v_lshl_add_u32 v79, v1, 5, s10
  v_subrev_f32 v8, s13, v68
  v_mul_f32 v8, s12, v8
  v_exp_f32 v8, v8
  v_mov_b32 v68, v69
  v_mov_b32 v69, v70
  v_mov_b32 v70, v71
  v_mov_b32 v71, v72
  v_mov_b32 v72, v73
  v_mov_b32 v73, v74
  v_mov_b32 v74, v75
  v_add_f32 v78, v78, v8
  v_cvt_pk_bf16_f32 v77, v8, v8
  s_nop 1
  v_and_b32_dpp v16, v77, v4 row_newbcast:0 row_mask:0xf bank_mask:0xf
  v_and_b32_dpp v17, v77, v5 row_newbcast:0 row_mask:0xf bank_mask:0xf
  v_and_b32_dpp v18, v77, v6 row_newbcast:0 row_mask:0xf bank_mask:0xf
  v_and_b32_dpp v19, v77, v7 row_newbcast:0 row_mask:0xf bank_mask:0xf
  v_and_b32_dpp v20, v77, v4 row_newbcast:4 row_mask:0xf bank_mask:0xf
  v_and_b32_dpp v21, v77, v5 row_newbcast:4 row_mask:0xf bank_mask:0xf
  v_and_b32_dpp v22, v77, v6 row_newbcast:4 row_mask:0xf bank_mask:0xf
  v_and_b32_dpp v23, v77, v7 row_newbcast:4 row_mask:0xf bank_mask:0xf
  v_mfma_f32_16x16x32_bf16 v[24:27], v[16:19], v[128:131], v[24:27]
  v_and_b32_dpp v16, v77, v4 row_newbcast:8 row_mask:0xf bank_mask:0xf
  v_and_b32_dpp v17, v77, v5 row_newbcast:8 row_mask:0xf bank_mask:0xf
  v_and_b32_dpp v18, v77, v6 row_newbcast:8 row_mask:0xf bank_mask:0xf
  v_and_b32_dpp v19, v77, v7 row_newbcast:8 row_mask:0xf bank_mask:0xf
  v_mfma_f32_16x16x32_bf16 v[24:27], v[20:23], v[132:135], v[24:27]
  v_and_b32_dpp v20, v77, v4 row_newbcast:12 row_mask:0xf bank_mask:0xf
  v_and_b32_dpp v21, v77, v5 row_newbcast:12 row_mask:0xf bank_mask:0xf
  v_and_b32_dpp v22, v77, v6 row_newbcast:12 row_mask:0xf bank_mask:0xf
  v_and_b32_dpp v23, v77, v7 row_newbcast:12 row_mask:0xf bank_mask:0xf
  v_mfma_f32_16x16x32_bf16 v[24:27], v[16:19], v[136:139], v[24:27]
  v_and_b32_dpp v16, v77, v4 row_newbcast:1 row_mask:0xf bank_mask:0xf
  v_and_b32_dpp v17, v77, v5 row_newbcast:1 row_mask:0xf bank_mask:0xf
  v_and_b32_dpp v18, v77, v6 row_newbcast:1 row_mask:0xf bank_mask:0xf
  v_and_b32_dpp v19, v77, v7 row_newbcast:1 row_mask:0xf bank_mask:0xf
  v_mfma_f32_16x16x32_bf16 v[24:27], v[20:23], v[140:143], v[24:27]
  v_and_b32_dpp v20, v77, v4 row_newbcast:5 row_mask:0xf bank_mask:0xf
  v_and_b32_dpp v21, v77, v5 row_newbcast:5 row_mask:0xf bank_mask:0xf
  v_and_b32_dpp v22, v77, v6 row_newbcast:5 row_mask:0xf bank_mask:0xf
  v_and_b32_dpp v23, v77, v7 row_newbcast:5 row_mask:0xf bank_mask:0xf
  v_mfma_f32_16x16x32_bf16 v[24:27], v[16:19], v[144:147], v[24:27]
  v_and_b32_dpp v16, v77, v4 row_newbcast:9 row_mask:0xf bank_mask:0xf
  v_and_b32_dpp v17, v77, v5 row_newbcast:9 row_mask:0xf bank_mask:0xf
  v_and_b32_dpp v18, v77, v6 row_newbcast:9 row_mask:0xf bank_mask:0xf
  v_and_b32_dpp v19, v77, v7 row_newbcast:9 row_mask:0xf bank_mask:0xf
  v_mfma_f32_16x16x32_bf16 v[24:27], v[20:23], v[148:151], v[24:27]
  v_and_b32_dpp v20, v77, v4 row_newbcast:13 row_mask:0xf bank_mask:0xf
  v_and_b32_dpp v21, v77, v5 row_newbcast:13 row_mask:0xf bank_mask:0xf
  v_and_b32_dpp v22, v77, v6 row_newbcast:13 row_mask:0xf bank_mask:0xf
  v_and_b32_dpp v23, v77, v7 row_newbcast:13 row_mask:0xf bank_mask:0xf
  v_mfma_f32_16x16x32_bf16 v[24:27], v[16:19], v[152:155], v[24:27]
  v_and_b32_dpp v16, v77, v4 row_newbcast:2 row_mask:0xf bank_mask:0xf
  v_and_b32_dpp v17, v77, v5 row_newbcast:2 row_mask:0xf bank_mask:0xf
  v_and_b32_dpp v18, v77, v6 row_newbcast:2 row_mask:0xf bank_mask:0xf
  v_and_b32_dpp v19, v77, v7 row_newbcast:2 row_mask:0xf bank_mask:0xf
  v_mfma_f32_16x16x32_bf16 v[24:27], v[20:23], v[156:159], v[24:27]
  v_and_b32_dpp v20, v77, v4 row_newbcast:6 row_mask:0xf bank_mask:0xf
  v_and_b32_dpp v21, v77, v5 row_newbcast:6 row_mask:0xf bank_mask:0xf
  v_and_b32_dpp v22, v77, v6 row_newbcast:6 row_mask:0xf bank_mask:0xf
  v_and_b32_dpp v23, v77, v7 row_newbcast:6 row_mask:0xf bank_mask:0xf
  v_mfma_f32_16x16x32_bf16 v[24:27], v[16:19], v[160:163], v[24:27]
  buffer_load_dwordx4 v[84:87], v32, s[48:51], s8 offen nt
  buffer_load_dwordx4 v[88:91], v33, s[48:51], s8 offen nt
  s_add_u32 s8, s8, 4608
  v_and_b32_dpp v16, v77, v4 row_newbcast:10 row_mask:0xf bank_mask:0xf
  v_and_b32_dpp v17, v77, v5 row_newbcast:10 row_mask:0xf bank_mask:0xf
  v_and_b32_dpp v18, v77, v6 row_newbcast:10 row_mask:0xf bank_mask:0xf
  v_and_b32_dpp v19, v77, v7 row_newbcast:10 row_mask:0xf bank_mask:0xf
  v_mfma_f32_16x16x32_bf16 v[24:27], v[20:23], v[164:167], v[24:27]
  buffer_load_dwordx4 v[92:95], v32, s[48:51], s8 offen nt
  buffer_load_dwordx4 v[96:99], v33, s[48:51], s8 offen nt
  s_add_u32 s8, s8, 4608
  v_and_b32_dpp v20, v77, v4 row_newbcast:14 row_mask:0xf bank_mask:0xf
  v_and_b32_dpp v21, v77, v5 row_newbcast:14 row_mask:0xf bank_mask:0xf
  v_and_b32_dpp v22, v77, v6 row_newbcast:14 row_mask:0xf bank_mask:0xf
  v_and_b32_dpp v23, v77, v7 row_newbcast:14 row_mask:0xf bank_mask:0xf
  v_mfma_f32_16x16x32_bf16 v[24:27], v[16:19], v[168:171], v[24:27]
  buffer_load_dwordx4 v[100:103], v32, s[48:51], s8 offen nt
  buffer_load_dwordx4 v[104:107], v33, s[48:51], s8 offen nt
  s_add_u32 s8, s8, 4608
  v_and_b32_dpp v16, v77, v4 row_newbcast:3 row_mask:0xf bank_mask:0xf
  v_and_b32_dpp v17, v77, v5 row_newbcast:3 row_mask:0xf bank_mask:0xf
  v_and_b32_dpp v18, v77, v6 row_newbcast:3 row_mask:0xf bank_mask:0xf
  v_and_b32_dpp v19, v77, v7 row_newbcast:3 row_mask:0xf bank_mask:0xf
  v_mfma_f32_16x16x32_bf16 v[24:27], v[20:23], v[172:175], v[24:27]
  buffer_load_dwordx4 v[108:111], v32, s[48:51], s8 offen nt
  buffer_load_dwordx4 v[112:115], v33, s[48:51], s8 offen nt
  s_add_u32 s8, s8, 4608
  v_and_b32_dpp v20, v77, v4 row_newbcast:7 row_mask:0xf bank_mask:0xf
  v_and_b32_dpp v21, v77, v5 row_newbcast:7 row_mask:0xf bank_mask:0xf
  v_and_b32_dpp v22, v77, v6 row_newbcast:7 row_mask:0xf bank_mask:0xf
  v_and_b32_dpp v23, v77, v7 row_newbcast:7 row_mask:0xf bank_mask:0xf
  v_mfma_f32_16x16x32_bf16 v[24:27], v[16:19], v[176:179], v[24:27]
  buffer_load_dwordx4 v[116:119], v34, s[48:51], s8 offen nt
  buffer_load_dwordx4 v[120:123], v35, s[48:51], s8 offen nt
  s_add_u32 s8, s8, 4608
  v_and_b32_dpp v16, v77, v4 row_newbcast:11 row_mask:0xf bank_mask:0xf
  v_and_b32_dpp v17, v77, v5 row_newbcast:11 row_mask:0xf bank_mask:0xf
  v_and_b32_dpp v18, v77, v6 row_newbcast:11 row_mask:0xf bank_mask:0xf
  v_and_b32_dpp v19, v77, v7 row_newbcast:11 row_mask:0xf bank_mask:0xf
  v_mfma_f32_16x16x32_bf16 v[24:27], v[20:23], v[180:183], v[24:27]
  v_and_b32_dpp v20, v77, v4 row_newbcast:15 row_mask:0xf bank_mask:0xf
  v_and_b32_dpp v21, v77, v5 row_newbcast:15 row_mask:0xf bank_mask:0xf
  v_and_b32_dpp v22, v77, v6 row_newbcast:15 row_mask:0xf bank_mask:0xf
  v_and_b32_dpp v23, v77, v7 row_newbcast:15 row_mask:0xf bank_mask:0xf
  v_mfma_f32_16x16x32_bf16 v[24:27], v[16:19], v[184:187], v[24:27]
  v_subrev_f32 v8, s13, v68
  v_mul_f32 v8, s12, v8
  v_exp_f32 v8, v8
  v_mov_b32 v68, v69
  v_mov_b32 v69, v70
  v_mov_b32 v70, v71
  v_mov_b32 v71, v72
  v_mov_b32 v72, v73
  v_mov_b32 v73, v74
  v_mov_b32 v74, v75
  v_add_f32 v78, v78, v8
  v_cvt_pk_bf16_f32 v77, v8, v8
  s_nop 1
  v_and_b32_dpp v16, v77, v4 row_newbcast:0 row_mask:0xf bank_mask:0xf
  v_and_b32_dpp v17, v77, v5 row_newbcast:0 row_mask:0xf bank_mask:0xf
  v_and_b32_dpp v18, v77, v6 row_newbcast:0 row_mask:0xf bank_mask:0xf
  v_and_b32_dpp v19, v77, v7 row_newbcast:0 row_mask:0xf bank_mask:0xf
  v_mfma_f32_16x16x32_bf16 v[24:27], v[20:23], v[188:191], v[24:27]
  v_and_b32_dpp v20, v77, v4 row_newbcast:4 row_mask:0xf bank_mask:0xf
  v_and_b32_dpp v21, v77, v5 row_newbcast:4 row_mask:0xf bank_mask:0xf
  v_and_b32_dpp v22, v77, v6 row_newbcast:4 row_mask:0xf bank_mask:0xf
  v_and_b32_dpp v23, v77, v7 row_newbcast:4 row_mask:0xf bank_mask:0xf
  v_mfma_f32_16x16x32_bf16 v[24:27], v[16:19], v[192:195], v[24:27]
  v_and_b32_dpp v16, v77, v4 row_newbcast:8 row_mask:0xf bank_mask:0xf
  v_and_b32_dpp v17, v77, v5 row_newbcast:8 row_mask:0xf bank_mask:0xf
  v_and_b32_dpp v18, v77, v6 row_newbcast:8 row_mask:0xf bank_mask:0xf
  v_and_b32_dpp v19, v77, v7 row_newbcast:8 row_mask:0xf bank_mask:0xf
  v_mfma_f32_16x16x32_bf16 v[24:27], v[20:23], v[196:199], v[24:27]
  s_nop 1
  v_add_f32_dpp v78, v78, v78 row_shr:1 row_mask:0xf bank_mask:0xf
  s_nop 1
  v_add_f32_dpp v78, v78, v78 row_shr:2 row_mask:0xf bank_mask:0xf
  s_nop 1
  v_add_f32_dpp v78, v78, v78 row_shr:4 row_mask:0xf bank_mask:0xf
  s_nop 1
  v_add_f32_dpp v78, v78, v78 row_shr:8 row_mask:0xf bank_mask:0xf
  s_nop 1
  v_add_f32_dpp v78, v78, v78 row_bcast:15 row_mask:0xa bank_mask:0xf
  s_nop 1
  v_add_f32_dpp v78, v78, v78 row_bcast:31 row_mask:0xc bank_mask:0xf
  s_nop 1
  v_mov_b32 v45, v78
  s_mov_b32 exec_lo, 0
  s_mov_b32 exec_hi, 0x80000000
  ds_write_b64 v83, v[44:45] offset:1024
  s_mov_b64 exec, -1
  v_and_b32 v8, 1, v1
  v_lshrrev_b32 v9, 2, v1
  v_lshlrev_b32 v9, 4, v9
  v_lshl_add_u32 v8, v8, 3, v9
  s_lshl_b32 s10, s3, 8
  v_add_u32 v68, s10, v8
  v_lshlrev_b32 v69, 4, v1
  v_and_b32 v8, 2, v1
  v_cmp_eq_u32 s[62:63], 0, v8
  v_mov_b32 v71, 512
  v_mov_b32 v72, 1
  v_mov_b32 v41, s15
  v_mov_b32 v43, s15
  s_lshl_b32 s60, s6, 14
  s_lshl_b32 s10, s3, 10
  s_add_u32 s60, s60, s10
  v_and_b32_dpp v20, v77, v4 row_newbcast:12 row_mask:0xf bank_mask:0xf
  v_and_b32_dpp v21, v77, v5 row_newbcast:12 row_mask:0xf bank_mask:0xf
  v_and_b32_dpp v22, v77, v6 row_newbcast:12 row_mask:0xf bank_mask:0xf
  v_and_b32_dpp v23, v77, v7 row_newbcast:12 row_mask:0xf bank_mask:0xf
  v_mfma_f32_16x16x32_bf16 v[24:27], v[16:19], v[200:203], v[24:27]
  v_and_b32_dpp v16, v77, v4 row_newbcast:1 row_mask:0xf bank_mask:0xf
  v_and_b32_dpp v17, v77, v5 row_newbcast:1 row_mask:0xf bank_mask:0xf
  v_and_b32_dpp v18, v77, v6 row_newbcast:1 row_mask:0xf bank_mask:0xf
  v_and_b32_dpp v19, v77, v7 row_newbcast:1 row_mask:0xf bank_mask:0xf
  v_mfma_f32_16x16x32_bf16 v[24:27], v[20:23], v[204:207], v[24:27]
  v_and_b32_dpp v20, v77, v4 row_newbcast:5 row_mask:0xf bank_mask:0xf
  v_and_b32_dpp v21, v77, v5 row_newbcast:5 row_mask:0xf bank_mask:0xf
  v_and_b32_dpp v22, v77, v6 row_newbcast:5 row_mask:0xf bank_mask:0xf
  v_and_b32_dpp v23, v77, v7 row_newbcast:5 row_mask:0xf bank_mask:0xf
  v_mfma_f32_16x16x32_bf16 v[24:27], v[16:19], v[208:211], v[24:27]
  v_and_b32_dpp v16, v77, v4 row_newbcast:9 row_mask:0xf bank_mask:0xf
  v_and_b32_dpp v17, v77, v5 row_newbcast:9 row_mask:0xf bank_mask:0xf
  v_and_b32_dpp v18, v77, v6 row_newbcast:9 row_mask:0xf bank_mask:0xf
  v_and_b32_dpp v19, v77, v7 row_newbcast:9 row_mask:0xf bank_mask:0xf
  v_mfma_f32_16x16x32_bf16 v[24:27], v[20:23], v[212:215], v[24:27]
  v_and_b32_dpp v20, v77, v4 row_newbcast:13 row_mask:0xf bank_mask:0xf
  v_and_b32_dpp v21, v77, v5 row_newbcast:13 row_mask:0xf bank_mask:0xf
  v_and_b32_dpp v22, v77, v6 row_newbcast:13 row_mask:0xf bank_mask:0xf
  v_and_b32_dpp v23, v77, v7 row_newbcast:13 row_mask:0xf bank_mask:0xf
  v_mfma_f32_16x16x32_bf16 v[24:27], v[16:19], v[216:219], v[24:27]
  v_and_b32_dpp v16, v77, v4 row_newbcast:2 row_mask:0xf bank_mask:0xf
  v_and_b32_dpp v17, v77, v5 row_newbcast:2 row_mask:0xf bank_mask:0xf
  v_and_b32_dpp v18, v77, v6 row_newbcast:2 row_mask:0xf bank_mask:0xf
  v_and_b32_dpp v19, v77, v7 row_newbcast:2 row_mask:0xf bank_mask:0xf
  s_waitcnt vmcnt(18)
  v_mfma_f32_16x16x32_bf16 v[24:27], v[20:23], v[220:223], v[24:27]
  v_and_b32_dpp v20, v77, v4 row_newbcast:6 row_mask:0xf bank_mask:0xf
  v_and_b32_dpp v21, v77, v5 row_newbcast:6 row_mask:0xf bank_mask:0xf
  v_and_b32_dpp v22, v77, v6 row_newbcast:6 row_mask:0xf bank_mask:0xf
  v_and_b32_dpp v23, v77, v7 row_newbcast:6 row_mask:0xf bank_mask:0xf
  s_waitcnt vmcnt(17)
  v_mfma_f32_16x16x32_bf16 v[24:27], v[16:19], v[224:227], v[24:27]
  v_and_b32_dpp v16, v77, v4 row_newbcast:10 row_mask:0xf bank_mask:0xf
  v_and_b32_dpp v17, v77, v5 row_newbcast:10 row_mask:0xf bank_mask:0xf
  v_and_b32_dpp v18, v77, v6 row_newbcast:10 row_mask:0xf bank_mask:0xf
  v_and_b32_dpp v19, v77, v7 row_newbcast:10 row_mask:0xf bank_mask:0xf
  s_waitcnt vmcnt(16)
  v_mfma_f32_16x16x32_bf16 v[24:27], v[20:23], v[228:231], v[24:27]
  v_and_b32_dpp v20, v77, v4 row_newbcast:14 row_mask:0xf bank_mask:0xf
  v_and_b32_dpp v21, v77, v5 row_newbcast:14 row_mask:0xf bank_mask:0xf
  v_and_b32_dpp v22, v77, v6 row_newbcast:14 row_mask:0xf bank_mask:0xf
  v_and_b32_dpp v23, v77, v7 row_newbcast:14 row_mask:0xf bank_mask:0xf
  s_waitcnt vmcnt(15)
  v_mfma_f32_16x16x32_bf16 v[24:27], v[16:19], v[232:235], v[24:27]
  v_and_b32_dpp v16, v77, v4 row_newbcast:3 row_mask:0xf bank_mask:0xf
  v_and_b32_dpp v17, v77, v5 row_newbcast:3 row_mask:0xf bank_mask:0xf
  v_and_b32_dpp v18, v77, v6 row_newbcast:3 row_mask:0xf bank_mask:0xf
  v_and_b32_dpp v19, v77, v7 row_newbcast:3 row_mask:0xf bank_mask:0xf
  s_waitcnt vmcnt(14)
  v_mfma_f32_16x16x32_bf16 v[24:27], v[20:23], v[236:239], v[24:27]
  v_and_b32_dpp v20, v77, v4 row_newbcast:7 row_mask:0xf bank_mask:0xf
  v_and_b32_dpp v21, v77, v5 row_newbcast:7 row_mask:0xf bank_mask:0xf
  v_and_b32_dpp v22, v77, v6 row_newbcast:7 row_mask:0xf bank_mask:0xf
  v_and_b32_dpp v23, v77, v7 row_newbcast:7 row_mask:0xf bank_mask:0xf
  s_waitcnt vmcnt(13)
  v_mfma_f32_16x16x32_bf16 v[24:27], v[16:19], v[240:243], v[24:27]
  v_and_b32_dpp v16, v77, v4 row_newbcast:11 row_mask:0xf bank_mask:0xf
  v_and_b32_dpp v17, v77, v5 row_newbcast:11 row_mask:0xf bank_mask:0xf
  v_and_b32_dpp v18, v77, v6 row_newbcast:11 row_mask:0xf bank_mask:0xf
  v_and_b32_dpp v19, v77, v7 row_newbcast:11 row_mask:0xf bank_mask:0xf
  s_waitcnt vmcnt(12)
  v_mfma_f32_16x16x32_bf16 v[24:27], v[20:23], v[244:247], v[24:27]
  v_and_b32_dpp v20, v77, v4 row_newbcast:15 row_mask:0xf bank_mask:0xf
  v_and_b32_dpp v21, v77, v5 row_newbcast:15 row_mask:0xf bank_mask:0xf
  v_and_b32_dpp v22, v77, v6 row_newbcast:15 row_mask:0xf bank_mask:0xf
  v_and_b32_dpp v23, v77, v7 row_newbcast:15 row_mask:0xf bank_mask:0xf
  s_waitcnt vmcnt(11)
  v_mfma_f32_16x16x32_bf16 v[24:27], v[16:19], v[248:251], v[24:27]
  s_nop 0
  s_waitcnt vmcnt(10)
  v_mfma_f32_16x16x32_bf16 v[24:27], v[20:23], v[252:255], v[24:27]
  s_nop 7
  s_mov_b32 exec_hi, 0
  ds_write_b128 v82, v[24:27] offset:1280
  s_mov_b32 exec_hi, -1
  s_waitcnt lgkmcnt(0)
  s_barrier
  ds_read_b32 v77, v37 offset:768
  s_waitcnt lgkmcnt(0)
  v_and_b32_dpp v16, v77, v4 row_newbcast:0 row_mask:0xf bank_mask:0xf
  v_and_b32_dpp v17, v77, v5 row_newbcast:0 row_mask:0xf bank_mask:0xf
  v_and_b32_dpp v18, v77, v6 row_newbcast:0 row_mask:0xf bank_mask:0xf
  v_and_b32_dpp v19, v77, v7 row_newbcast:0 row_mask:0xf bank_mask:0xf
  s_waitcnt vmcnt(8)
  s_nop 0
  v_mfma_f32_16x16x32_bf16 v[24:27], v[16:19], v[84:87], 0
  v_mfma_f32_16x16x32_bf16 v[28:31], v[16:19], v[88:91], 0
  v_and_b32_dpp v20, v77, v4 row_newbcast:1 row_mask:0xf bank_mask:0xf
  v_and_b32_dpp v21, v77, v5 row_newbcast:1 row_mask:0xf bank_mask:0xf
  v_and_b32_dpp v22, v77, v6 row_newbcast:1 row_mask:0xf bank_mask:0xf
  v_and_b32_dpp v23, v77, v7 row_newbcast:1 row_mask:0xf bank_mask:0xf
  s_waitcnt vmcnt(6)
  s_nop 0
  v_mfma_f32_16x16x32_bf16 v[24:27], v[20:23], v[92:95], v[24:27]
  v_mfma_f32_16x16x32_bf16 v[28:31], v[20:23], v[96:99], v[28:31]
  v_and_b32_dpp v16, v77, v4 row_newbcast:2 row_mask:0xf bank_mask:0xf
  v_and_b32_dpp v17, v77, v5 row_newbcast:2 row_mask:0xf bank_mask:0xf
  v_and_b32_dpp v18, v77, v6 row_newbcast:2 row_mask:0xf bank_mask:0xf
  v_and_b32_dpp v19, v77, v7 row_newbcast:2 row_mask:0xf bank_mask:0xf
  s_waitcnt vmcnt(4)
  s_nop 0
  v_mfma_f32_16x16x32_bf16 v[24:27], v[16:19], v[100:103], v[24:27]
  v_mfma_f32_16x16x32_bf16 v[28:31], v[16:19], v[104:107], v[28:31]
  v_and_b32_dpp v20, v77, v4 row_newbcast:3 row_mask:0xf bank_mask:0xf
  v_and_b32_dpp v21, v77, v5 row_newbcast:3 row_mask:0xf bank_mask:0xf
  v_and_b32_dpp v22, v77, v6 row_newbcast:3 row_mask:0xf bank_mask:0xf
  v_and_b32_dpp v23, v77, v7 row_newbcast:3 row_mask:0xf bank_mask:0xf
  s_waitcnt vmcnt(2)
  s_nop 0
  v_mfma_f32_16x16x32_bf16 v[24:27], v[20:23], v[108:111], v[24:27]
  v_mfma_f32_16x16x32_bf16 v[28:31], v[20:23], v[112:115], v[28:31]
  v_and_b32_dpp v16, v77, v4 row_newbcast:4 row_mask:0xf bank_mask:0xf
  v_and_b32_dpp v17, v77, v5 row_newbcast:4 row_mask:0xf bank_mask:0xf
  v_and_b32_dpp v18, v77, v6 row_newbcast:4 row_mask:0xf bank_mask:0xf
  v_and_b32_dpp v19, v77, v7 row_newbcast:4 row_mask:0xf bank_mask:0xf
  s_waitcnt vmcnt(0)
  s_nop 0
  v_mfma_f32_16x16x32_bf16 v[24:27], v[16:19], v[116:119], v[24:27]
  v_mfma_f32_16x16x32_bf16 v[28:31], v[16:19], v[120:123], v[28:31]
  s_nop 7
  s_mov_b32 exec_hi, 0
  ds_write_b128 v36, v[24:27] offset:3328
  s_mov_b32 exec_lo, 0x00030003
  ds_write_b128 v36, v[28:31] offset:3840
  s_mov_b64 exec, -1
  s_mov_b32 s56, s34
  s_mov_b32 s57, s35
  s_mov_b32 s58, 1152
  s_mov_b32 s59, 0x20000
  v_lshrrev_b32 v8, 2, v1
  v_and_b32 v11, 3, v1
  v_lshlrev_b32 v12, 14, v8
  v_lshl_add_u32 v12, v11, 4, v12
  s_lshl_b32 s10, s0, 6
  v_add_u32 v12, s10, v12
  v_lshlrev_b32 v13, 2, v8
  v_add_u32 v13, 5632, v13
  v_and_b32 v14, 1, v1
  v_cmp_eq_u32 vcc, 1, v14
  s_lshl_b32 s10, s0, 3
  v_lshl_add_u32 v10, v14, 2, s10
  v_cndmask_b32 v92, v80, v81, vcc
  v_and_b32 v93, 0xffff0000, v92
  v_lshlrev_b32 v92, 16, v92
  v_mov_b32 v9, 1073741824
  v_cmp_gt_u32 vcc, 2, v1
  s_mov_b32 s12, 1069066811
  v_lshlrev_b32 v97, 5, v1
  v_cndmask_b32 v96, v9, v10, vcc
  s_waitcnt lgkmcnt(0)
  s_barrier
  ds_read_b64 v[48:49], v68 offset:8192
  ds_read_b64 v[50:51], v68 offset:10496
  ds_read_b64 v[52:53], v68 offset:12800
  ds_read_b64 v[54:55], v68 offset:15104
  ds_read_b64 v[56:57], v68 offset:3328
  s_waitcnt lgkmcnt(1)
  v_add_f32 v48, v48, v50
  v_add_f32 v52, v52, v54
  v_add_f32 v49, v49, v51
  v_add_f32 v53, v53, v55
  v_add_f32 v48, v48, v52
  v_add_f32 v49, v49, v53
  s_waitcnt lgkmcnt(0)
  v_cndmask_b32 v40, v56, v48, s[62:63]
  v_cndmask_b32 v42, v57, v49, s[62:63]
  buffer_store_dwordx4 v[40:43], v69, s[52:55], s60 offen offset:0 sc1
  s_cmp_lg_u32 s3, 3
  s_cbranch_scc1 L_fin
  s_cmp_ge_u32 s2, 144
  s_cbranch_scc1 L_fin
  s_mov_b64 s[44:45], -1
  s_mov_b64 s[46:47], -1
  s_mov_b32 s14, 0
  s_branch L_fp_m
L_fp_ms:
  s_sleep 4
L_fp_m:
  buffer_load_dwordx4 v[208:211], v97, s[52:55], s64 offen sc1
  buffer_load_dwordx4 v[212:215], v97, s[52:55], s65 offen sc1
  buffer_load_dwordx4 v[216:219], v97, s[52:55], s66 offen sc1
  buffer_load_dwordx4 v[220:223], v97, s[52:55], s67 offen sc1
  s_add_u32 s14, s14, 1
  s_waitcnt vmcnt(0)
  s_memrealtime s[76:77]
  v_bitop3_b32 v9, v209, v211, s15 bitop3:0x7e
  v_bitop3_b32 v10, v213, v215, s15 bitop3:0x7e
  v_bitop3_b32 v15, v217, v219, s15 bitop3:0x7e
  v_or3_b32 v9, v9, v10, v15
  v_bitop3_b32 v10, v221, v223, s15 bitop3:0x7e
  v_or_b32 v9, v9, v10
  v_cmp_ne_u32 vcc, 0, v9
  s_cmp_ge_u32 s14, 262144
  s_cbranch_scc1 L_fp_m2
  s_and_b64 exec, exec, vcc
  s_cbranch_execnz L_fp_ms
L_fp_m2:
  s_mov_b64 exec, -1
  s_waitcnt lgkmcnt(0)
  v_sub_u32 v209, s76, v208
  v_and_b32 v209, 0xffff, v209
  v_and_b32 v208, 0xffff0000, v208
  v_sub_u32 v213, s76, v212
  v_and_b32 v213, 0xffff, v213
  v_and_b32 v212, 0xffff0000, v212
  v_sub_u32 v217, s76, v216
  v_and_b32 v217, 0xffff, v217
  v_and_b32 v216, 0xffff0000, v216
  v_sub_u32 v221, s76, v220
  v_and_b32 v221, 0xffff, v221
  v_and_b32 v220, 0xffff0000, v220
  v_min3_u32 v9, v209, v213, v217
  v_min_u32 v9, v9, v221
  v_cmp_gt_u32 vcc, 100, v9
  s_cbranch_vccz L_tb2
  s_nop 1
  v_min_u32_dpp v9, v9, v9 row_shr:1 row_mask:0xf bank_mask:0xf
  s_nop 1
  v_min_u32_dpp v9, v9, v9 row_shr:2 row_mask:0xf bank_mask:0xf
  s_nop 1
  v_min_u32_dpp v9, v9, v9 row_shr:4 row_mask:0xf bank_mask:0xf
  s_nop 1
  v_min_u32_dpp v9, v9, v9 row_shr:8 row_mask:0xf bank_mask:0xf
  s_nop 1
  v_min_u32_dpp v9, v9, v9 row_bcast:15 row_mask:0xa bank_mask:0xf
  s_nop 1
  v_min_u32_dpp v9, v9, v9 row_bcast:31 row_mask:0xc bank_mask:0xf
  s_nop 1
  v_readlane_b32 s76, v9, 63
  s_sub_i32 s76, 100, s76
  s_mul_i32 s76, s76, 72
  s_ashr_i32 s76, s76, 8
L_tb:
  s_cmp_gt_i32 s76, 0
  s_cbranch_scc0 L_tb2
  s_sleep 1
  s_sub_u32 s76, s76, 1
  s_branch L_tb
L_tb2:
  s_mov_b64 exec, s[46:47]
  s_cbranch_execz L_fp_w
  s_mov_b32 s10, 0
  buffer_load_dwordx4 v[144:147], v12, s[52:55], s10 offen sc1
  s_add_u32 s10, s10, 262144
  buffer_load_dwordx4 v[148:151], v12, s[52:55], s10 offen sc1
  s_add_u32 s10, s10, 262144
  buffer_load_dwordx4 v[152:155], v12, s[52:55], s10 offen sc1
  s_add_u32 s10, s10, 262144
  buffer_load_dwordx4 v[156:159], v12, s[52:55], s10 offen sc1
  s_add_u32 s10, s10, 262144
  buffer_load_dwordx4 v[160:163], v12, s[52:55], s10 offen sc1
  s_add_u32 s10, s10, 262144
  buffer_load_dwordx4 v[164:167], v12, s[52:55], s10 offen sc1
  s_add_u32 s10, s10, 262144
  buffer_load_dwordx4 v[168:171], v12, s[52:55], s10 offen sc1
  s_add_u32 s10, s10, 262144
  buffer_load_dwordx4 v[172:175], v12, s[52:55], s10 offen sc1
  s_add_u32 s10, s10, 262144
  buffer_load_dwordx4 v[176:179], v12, s[52:55], s10 offen sc1
  s_add_u32 s10, s10, 262144
  buffer_load_dwordx4 v[180:183], v12, s[52:55], s10 offen sc1
  s_add_u32 s10, s10, 262144
  buffer_load_dwordx4 v[184:187], v12, s[52:55], s10 offen sc1
  s_add_u32 s10, s10, 262144
  buffer_load_dwordx4 v[188:191], v12, s[52:55], s10 offen sc1
  s_add_u32 s10, s10, 262144
  buffer_load_dwordx4 v[192:195], v12, s[52:55], s10 offen sc1
  s_add_u32 s10, s10, 262144
  buffer_load_dwordx4 v[196:199], v12, s[52:55], s10 offen sc1
  s_add_u32 s10, s10, 262144
  buffer_load_dwordx4 v[200:203], v12, s[52:55], s10 offen sc1
  s_add_u32 s10, s10, 262144
  buffer_load_dwordx4 v[204:207], v12, s[52:55], s10 offen sc1
L_fp_w:
  s_mov_b64 exec, -1
  v_mov_b32 v209, v208
  v_mov_b32 v213, v212
  v_mov_b32 v217, v216
  v_mov_b32 v221, v220
  v_max_f32_dpp v209, v209, v209 quad_perm:[1,0,3,2] row_mask:0xf bank_mask:0xf
  v_max_f32_dpp v213, v213, v213 quad_perm:[1,0,3,2] row_mask:0xf bank_mask:0xf
  v_max_f32_dpp v217, v217, v217 quad_perm:[1,0,3,2] row_mask:0xf bank_mask:0xf
  v_max_f32_dpp v221, v221, v221 quad_perm:[1,0,3,2] row_mask:0xf bank_mask:0xf
  v_max_f32_dpp v209, v209, v209 quad_perm:[2,3,0,1] row_mask:0xf bank_mask:0xf
  v_max_f32_dpp v213, v213, v213 quad_perm:[2,3,0,1] row_mask:0xf bank_mask:0xf
  v_max_f32_dpp v217, v217, v217 quad_perm:[2,3,0,1] row_mask:0xf bank_mask:0xf
  v_max_f32_dpp v221, v221, v221 quad_perm:[2,3,0,1] row_mask:0xf bank_mask:0xf
  v_max_f32_dpp v209, v209, v209 row_half_mirror row_mask:0xf bank_mask:0xf
  v_max_f32_dpp v213, v213, v213 row_half_mirror row_mask:0xf bank_mask:0xf
  v_max_f32_dpp v217, v217, v217 row_half_mirror row_mask:0xf bank_mask:0xf
  v_max_f32_dpp v221, v221, v221 row_half_mirror row_mask:0xf bank_mask:0xf
  v_sub_f32 v208, v208, v209
  v_sub_f32 v212, v212, v213
  v_sub_f32 v216, v216, v217
  v_sub_f32 v220, v220, v221
  v_mul_f32 v208, s12, v208
  v_mul_f32 v212, s12, v212
  v_mul_f32 v216, s12, v216
  v_mul_f32 v220, s12, v220
  v_exp_f32 v208, v208
  v_exp_f32 v212, v212
  v_exp_f32 v216, v216
  v_exp_f32 v220, v220
  v_mul_f32 v210, v208, v210
  v_mul_f32 v214, v212, v214
  v_mul_f32 v218, v216, v218
  v_mul_f32 v222, v220, v222
  v_add_f32_dpp v210, v210, v210 quad_perm:[1,0,3,2] row_mask:0xf bank_mask:0xf
  v_add_f32_dpp v214, v214, v214 quad_perm:[1,0,3,2] row_mask:0xf bank_mask:0xf
  v_add_f32_dpp v218, v218, v218 quad_perm:[1,0,3,2] row_mask:0xf bank_mask:0xf
  v_add_f32_dpp v222, v222, v222 quad_perm:[1,0,3,2] row_mask:0xf bank_mask:0xf
  v_add_f32_dpp v210, v210, v210 quad_perm:[2,3,0,1] row_mask:0xf bank_mask:0xf
  v_add_f32_dpp v214, v214, v214 quad_perm:[2,3,0,1] row_mask:0xf bank_mask:0xf
  v_add_f32_dpp v218, v218, v218 quad_perm:[2,3,0,1] row_mask:0xf bank_mask:0xf
  v_add_f32_dpp v222, v222, v222 quad_perm:[2,3,0,1] row_mask:0xf bank_mask:0xf
  v_add_f32_dpp v210, v210, v210 row_half_mirror row_mask:0xf bank_mask:0xf
  v_add_f32_dpp v214, v214, v214 row_half_mirror row_mask:0xf bank_mask:0xf
  v_add_f32_dpp v218, v218, v218 row_half_mirror row_mask:0xf bank_mask:0xf
  v_add_f32_dpp v222, v222, v222 row_half_mirror row_mask:0xf bank_mask:0xf
  v_rcp_f32 v210, v210
  v_rcp_f32 v214, v214
  v_rcp_f32 v218, v218
  v_rcp_f32 v222, v222
  v_mul_f32 v208, v208, v210
  v_mul_f32 v212, v212, v214
  v_mul_f32 v216, v216, v218
  v_mul_f32 v220, v220, v222
  ds_write_b32 v37, v208 offset:5632
  ds_write_b32 v37, v212 offset:5888
  ds_write_b32 v37, v216 offset:6144
  ds_write_b32 v37, v220 offset:6400
  s_waitcnt lgkmcnt(0)
  ds_read_b32 v128, v13 offset:0
  ds_read_b32 v129, v13 offset:64
  ds_read_b32 v130, v13 offset:128
  ds_read_b32 v131, v13 offset:192
  ds_read_b32 v132, v13 offset:256
  ds_read_b32 v133, v13 offset:320
  ds_read_b32 v134, v13 offset:384
  ds_read_b32 v135, v13 offset:448
  ds_read_b32 v136, v13 offset:512
  ds_read_b32 v137, v13 offset:576
  ds_read_b32 v138, v13 offset:640
  ds_read_b32 v139, v13 offset:704
  s_waitcnt lgkmcnt(8)
  ds_read_b32 v140, v13 offset:768
  ds_read_b32 v141, v13 offset:832
  ds_read_b32 v142, v13 offset:896
  ds_read_b32 v143, v13 offset:960
  s_waitcnt lgkmcnt(0)
  v_cndmask_b32 v128, 1.0, v128, s[62:63]
  v_cndmask_b32 v129, 1.0, v129, s[62:63]
  v_cndmask_b32 v130, 1.0, v130, s[62:63]
  v_cndmask_b32 v131, 1.0, v131, s[62:63]
  v_cndmask_b32 v132, 1.0, v132, s[62:63]
  v_cndmask_b32 v133, 1.0, v133, s[62:63]
  v_cndmask_b32 v134, 1.0, v134, s[62:63]
  v_cndmask_b32 v135, 1.0, v135, s[62:63]
  v_cndmask_b32 v136, 1.0, v136, s[62:63]
  v_cndmask_b32 v137, 1.0, v137, s[62:63]
  v_cndmask_b32 v138, 1.0, v138, s[62:63]
  v_cndmask_b32 v139, 1.0, v139, s[62:63]
  v_cndmask_b32 v140, 1.0, v140, s[62:63]
  v_cndmask_b32 v141, 1.0, v141, s[62:63]
  v_cndmask_b32 v142, 1.0, v142, s[62:63]
  v_cndmask_b32 v143, 1.0, v143, s[62:63]
  s_waitcnt vmcnt(12)
  v_bitop3_b32 v9, v145, v147, s15 bitop3:0x7e
  v_bitop3_b32 v10, v149, v151, s15 bitop3:0x7e
  v_bitop3_b32 v15, v153, v155, s15 bitop3:0x7e
  v_or3_b32 v9, v9, v10, v15
  v_bitop3_b32 v10, v157, v159, s15 bitop3:0x7e
  v_or_b32 v9, v9, v10
  v_mul_f32 v88, v128, v144
  v_mul_f32 v89, v128, v146
  v_mul_f32 v90, v129, v148
  v_mul_f32 v91, v129, v150
  v_fmac_f32 v88, v130, v152
  v_fmac_f32 v89, v130, v154
  v_fmac_f32 v90, v131, v156
  v_fmac_f32 v91, v131, v158
  s_waitcnt vmcnt(8)
  v_bitop3_b32 v14, v161, v163, s15 bitop3:0x7e
  v_bitop3_b32 v10, v165, v167, s15 bitop3:0x7e
  v_bitop3_b32 v15, v169, v171, s15 bitop3:0x7e
  v_or3_b32 v14, v14, v10, v15
  v_bitop3_b32 v10, v173, v175, s15 bitop3:0x7e
  v_or_b32 v14, v14, v10
  v_or_b32 v9, v9, v14
  v_fmac_f32 v88, v132, v160
  v_fmac_f32 v89, v132, v162
  v_fmac_f32 v90, v133, v164
  v_fmac_f32 v91, v133, v166
  v_fmac_f32 v88, v134, v168
  v_fmac_f32 v89, v134, v170
  v_fmac_f32 v90, v135, v172
  v_fmac_f32 v91, v135, v174
  s_waitcnt vmcnt(4)
  v_bitop3_b32 v14, v177, v179, s15 bitop3:0x7e
  v_bitop3_b32 v10, v181, v183, s15 bitop3:0x7e
  v_bitop3_b32 v15, v185, v187, s15 bitop3:0x7e
  v_or3_b32 v14, v14, v10, v15
  v_bitop3_b32 v10, v189, v191, s15 bitop3:0x7e
  v_or_b32 v14, v14, v10
  v_or_b32 v9, v9, v14
  v_fmac_f32 v88, v136, v176
  v_fmac_f32 v89, v136, v178
  v_fmac_f32 v90, v137, v180
  v_fmac_f32 v91, v137, v182
  v_fmac_f32 v88, v138, v184
  v_fmac_f32 v89, v138, v186
  v_fmac_f32 v90, v139, v188
  v_fmac_f32 v91, v139, v190
  s_waitcnt vmcnt(0)
  v_bitop3_b32 v14, v193, v195, s15 bitop3:0x7e
  v_bitop3_b32 v10, v197, v199, s15 bitop3:0x7e
  v_bitop3_b32 v15, v201, v203, s15 bitop3:0x7e
  v_or3_b32 v14, v14, v10, v15
  v_bitop3_b32 v10, v205, v207, s15 bitop3:0x7e
  v_or_b32 v14, v14, v10
  v_or_b32 v9, v9, v14
  v_fmac_f32 v88, v140, v192
  v_fmac_f32 v89, v140, v194
  v_fmac_f32 v90, v141, v196
  v_fmac_f32 v91, v141, v198
  v_fmac_f32 v88, v142, v200
  v_fmac_f32 v89, v142, v202
  v_fmac_f32 v90, v143, v204
  v_fmac_f32 v91, v143, v206
  v_cmp_ne_u32 vcc, 0, v9
  s_and_b64 exec, exec, vcc
  s_cbranch_execnz L_fp_r
  s_mov_b64 exec, -1
  s_branch L_fp_sum
L_fp_r:
  s_mov_b32 s10, 0
  buffer_load_dwordx4 v[144:147], v12, s[52:55], s10 offen sc1
  s_add_u32 s10, s10, 262144
  buffer_load_dwordx4 v[148:151], v12, s[52:55], s10 offen sc1
  s_add_u32 s10, s10, 262144
  buffer_load_dwordx4 v[152:155], v12, s[52:55], s10 offen sc1
  s_add_u32 s10, s10, 262144
  buffer_load_dwordx4 v[156:159], v12, s[52:55], s10 offen sc1
  s_add_u32 s10, s10, 262144
  buffer_load_dwordx4 v[160:163], v12, s[52:55], s10 offen sc1
  s_add_u32 s10, s10, 262144
  buffer_load_dwordx4 v[164:167], v12, s[52:55], s10 offen sc1
  s_add_u32 s10, s10, 262144
  buffer_load_dwordx4 v[168:171], v12, s[52:55], s10 offen sc1
  s_add_u32 s10, s10, 262144
  buffer_load_dwordx4 v[172:175], v12, s[52:55], s10 offen sc1
  s_add_u32 s10, s10, 262144
  buffer_load_dwordx4 v[176:179], v12, s[52:55], s10 offen sc1
  s_add_u32 s10, s10, 262144
  buffer_load_dwordx4 v[180:183], v12, s[52:55], s10 offen sc1
  s_add_u32 s10, s10, 262144
  buffer_load_dwordx4 v[184:187], v12, s[52:55], s10 offen sc1
  s_add_u32 s10, s10, 262144
  buffer_load_dwordx4 v[188:191], v12, s[52:55], s10 offen sc1
  s_add_u32 s10, s10, 262144
  buffer_load_dwordx4 v[192:195], v12, s[52:55], s10 offen sc1
  s_add_u32 s10, s10, 262144
  buffer_load_dwordx4 v[196:199], v12, s[52:55], s10 offen sc1
  s_add_u32 s10, s10, 262144
  buffer_load_dwordx4 v[200:203], v12, s[52:55], s10 offen sc1
  s_add_u32 s10, s10, 262144
  buffer_load_dwordx4 v[204:207], v12, s[52:55], s10 offen sc1
L_fp_c:
  s_add_u32 s14, s14, 1
  s_waitcnt vmcnt(0)
  v_bitop3_b32 v9, v145, v147, s15 bitop3:0x7e
  v_bitop3_b32 v10, v149, v151, s15 bitop3:0x7e
  v_bitop3_b32 v15, v153, v155, s15 bitop3:0x7e
  v_or3_b32 v9, v9, v10, v15
  v_bitop3_b32 v10, v157, v159, s15 bitop3:0x7e
  v_bitop3_b32 v15, v161, v163, s15 bitop3:0x7e
  v_or3_b32 v9, v9, v10, v15
  v_bitop3_b32 v10, v165, v167, s15 bitop3:0x7e
  v_bitop3_b32 v15, v169, v171, s15 bitop3:0x7e
  v_or3_b32 v9, v9, v10, v15
  v_bitop3_b32 v10, v173, v175, s15 bitop3:0x7e
  v_bitop3_b32 v15, v177, v179, s15 bitop3:0x7e
  v_or3_b32 v9, v9, v10, v15
  v_bitop3_b32 v10, v181, v183, s15 bitop3:0x7e
  v_bitop3_b32 v15, v185, v187, s15 bitop3:0x7e
  v_or3_b32 v9, v9, v10, v15
  v_bitop3_b32 v10, v189, v191, s15 bitop3:0x7e
  v_bitop3_b32 v15, v193, v195, s15 bitop3:0x7e
  v_or3_b32 v9, v9, v10, v15
  v_bitop3_b32 v10, v197, v199, s15 bitop3:0x7e
  v_bitop3_b32 v15, v201, v203, s15 bitop3:0x7e
  v_or3_b32 v9, v9, v10, v15
  v_bitop3_b32 v10, v205, v207, s15 bitop3:0x7e
  v_or_b32 v9, v9, v10
  v_cmp_ne_u32 vcc, 0, v9
  s_cmp_ge_u32 s14, 262144
  s_cbranch_scc1 L_fp_done
  s_and_b64 exec, exec, vcc
  s_cbranch_execnz L_fp_r
L_fp_done:
  s_mov_b64 exec, -1
  v_mul_f32 v88, v128, v144
  v_mul_f32 v89, v128, v146
  v_mul_f32 v90, v129, v148
  v_mul_f32 v91, v129, v150
  v_fmac_f32 v88, v130, v152
  v_fmac_f32 v89, v130, v154
  v_fmac_f32 v90, v131, v156
  v_fmac_f32 v91, v131, v158
  v_fmac_f32 v88, v132, v160
  v_fmac_f32 v89, v132, v162
  v_fmac_f32 v90, v133, v164
  v_fmac_f32 v91, v133, v166
  v_fmac_f32 v88, v134, v168
  v_fmac_f32 v89, v134, v170
  v_fmac_f32 v90, v135, v172
  v_fmac_f32 v91, v135, v174
  v_fmac_f32 v88, v136, v176
  v_fmac_f32 v89, v136, v178
  v_fmac_f32 v90, v137, v180
  v_fmac_f32 v91, v137, v182
  v_fmac_f32 v88, v138, v184
  v_fmac_f32 v89, v138, v186
  v_fmac_f32 v90, v139, v188
  v_fmac_f32 v91, v139, v190
  v_fmac_f32 v88, v140, v192
  v_fmac_f32 v89, v140, v194
  v_fmac_f32 v90, v141, v196
  v_fmac_f32 v91, v141, v198
  v_fmac_f32 v88, v142, v200
  v_fmac_f32 v89, v142, v202
  v_fmac_f32 v90, v143, v204
  v_fmac_f32 v91, v143, v206
L_fp_sum:
  v_add_f32 v88, v88, v90
  v_add_f32 v89, v89, v91
  s_nop 0
  v_add_f32_dpp v88, v88, v88 row_ror:4 row_mask:0xf bank_mask:0xf
  v_add_f32_dpp v89, v89, v89 row_ror:4 row_mask:0xf bank_mask:0xf
  s_nop 0
  v_add_f32_dpp v88, v88, v88 row_ror:8 row_mask:0xf bank_mask:0xf
  v_add_f32_dpp v89, v89, v89 row_ror:8 row_mask:0xf bank_mask:0xf
  s_nop 0
  v_mov_b32 v14, v88
  v_mov_b32 v15, v89
  s_nop 1
  v_permlane16_swap_b32 v14, v88
  v_permlane16_swap_b32 v15, v89
  v_add_f32 v88, v88, v14
  v_add_f32 v89, v89, v15
  v_mov_b32 v14, v88
  v_mov_b32 v15, v89
  s_nop 1
  v_permlane32_swap_b32 v14, v88
  v_permlane32_swap_b32 v15, v89
  v_add_f32 v88, v88, v14
  v_add_f32 v89, v89, v15
  v_cvt_pk_bf16_f32 v88, v88, v88
  v_cvt_pk_bf16_f32 v89, v89, v89
  v_lshlrev_b32 v88, 16, v88
  v_lshlrev_b32 v89, 16, v89
  v_add_f32 v90, v92, v88
  v_add_f32 v91, v93, v89
  v_cvt_pk_bf16_f32 v90, v90, v90
  v_cvt_pk_bf16_f32 v91, v91, v91
  v_lshlrev_b32 v90, 16, v90
  v_lshlrev_b32 v91, 16, v91
  v_add_f32_dpp v90, v88, v90 quad_perm:[2,3,2,3] row_mask:0xf bank_mask:0xf
  v_add_f32_dpp v91, v89, v91 quad_perm:[2,3,2,3] row_mask:0xf bank_mask:0xf
  v_cvt_pk_bf16_f32 v12, v90, v91
  buffer_store_dword v12, v96, s[56:59], 0 offen
  s_cmp_lg_u32 s2, 0
  s_cbranch_scc1 L_fin
  v_mov_b32 v10, s15
  v_mov_b32 v11, 5898240
  s_mov_b64 exec, 1
  buffer_store_dword v10, v11, s[52:55], 0 offen
  s_endpgm
L_fin:
L_end:
  s_endpgm
L_codeend:
.section .rodata,"a"
.p2align 6
.amdhsa_kernel parallel_sum__mha_block_cached__glu_gated_bilinear__decode_kernel
  .amdhsa_next_free_vgpr 256
  .amdhsa_next_free_sgpr 102
  .amdhsa_accum_offset 256
  .amdhsa_group_segment_fixed_size 0
  .amdhsa_kernarg_size 96
  .amdhsa_user_sgpr_count 2
  .amdhsa_user_sgpr_kernarg_segment_ptr 1
  .amdhsa_system_sgpr_workgroup_id_x 1
.end_amdhsa_kernel
```
